```python
import torch

def _softmax(x, axis=-1):
    return torch.softmax(x, dim=axis)
def _gelu(x):
    return torch.nn.functional.gelu(x, approximate="tanh")
def _silu(x):
    return torch.nn.functional.silu(x)
def _sigmoid(x):
    return torch.sigmoid(x)
def _layernorm(x, axis=-1, eps=1e-5):
    m = x.mean(dim=axis, keepdim=True)
    v = x.var(dim=axis, keepdim=True, unbiased=False)
    return (x - m) / torch.sqrt(v + eps)
def _scatter_add(tgt, idx, src, axis=0):
    return tgt.clone().index_add_(axis, idx, src)
def _segment_sum(src, seg, n):
    out = torch.zeros((n,) + src.shape[1:], dtype=src.dtype)
    return out.index_add_(0, seg, src)
def _pad(x, pw):
    flat = tuple(v for pair in reversed(pw) for v in pair)
    return torch.nn.functional.pad(x, flat)

kernel_name = 'parallel_sum__ssm_conv_s4__dense_activation_squared_relu__prompt'

def setup_inputs():

    _w = (lambda a: (lambda t: t.to(torch.bfloat16) if t.is_floating_point() else t)(torch.as_tensor(a)))
    def _A_setup():
        B, L, D, N = 1, 2048, 512, 128
        A_re = -(lambda _x: torch.exp(torch.as_tensor(_x)))((lambda *s: torch.randn(*s, dtype=torch.bfloat16) * 3.2)(D, N))
        A_im = torch.pi * (lambda *s: torch.randn(*s, dtype=torch.bfloat16) * 0.2)(D, N)
        B_re = (lambda *s: torch.randn(*s, dtype=torch.bfloat16) * 0.4)(D, N)
        B_im = (lambda *s: torch.randn(*s, dtype=torch.bfloat16) * 0.4)(D, N)
        C_re = (lambda *s: torch.randn(*s, dtype=torch.bfloat16) * 0.4)(D, N)
        C_im = (lambda *s: torch.randn(*s, dtype=torch.bfloat16) * 0.4)(D, N)
        log_dt = (lambda *s: torch.randn(*s, dtype=torch.bfloat16) * 0.2)(D) * 0.5 - 4.0
        Dskip = (lambda *s: torch.randn(*s, dtype=torch.bfloat16) * 0.4)(D)
        return {
            "u": _w((lambda *s: torch.randn(*s, dtype=torch.bfloat16) * 0.05)(B, L, D)),
            "A_re": _w(A_re),
            "A_im": _w(A_im),
            "B_re": _w(B_re),
            "B_im": _w(B_im),
            "C_re": _w(C_re),
            "C_im": _w(C_im),
            "log_dt": _w(log_dt),
            "Dskip": _w(Dskip),
        }
    _A_in = _A_setup()

    def _B_setup():
        B, S, D, F = 1, 2048, 512, 1792
        return {
            "x": _w((lambda *s: torch.randn(*s, dtype=torch.bfloat16) * 0.05)(B, S, D)),
            "w1": _w((lambda *s: torch.randn(*s, dtype=torch.bfloat16) * 0.05)(D, F)),
            "b1": _w((lambda *s: torch.randn(*s, dtype=torch.bfloat16) * 0.2)(F)),
            "w2": _w((lambda *s: torch.randn(*s, dtype=torch.bfloat16) * 0.05)(F, D)),
            "b2": _w((lambda *s: torch.randn(*s, dtype=torch.bfloat16) * 0.8)(D)),
        }
    _B_in = _B_setup()

    return {
        "A_u": _A_in["u"],
        "A_A_re": _A_in["A_re"],
        "A_A_im": _A_in["A_im"],
        "A_B_re": _A_in["B_re"],
        "A_B_im": _A_in["B_im"],
        "A_C_re": _A_in["C_re"],
        "A_C_im": _A_in["C_im"],
        "A_log_dt": _A_in["log_dt"],
        "A_Dskip": _A_in["Dskip"],
        "B_x": _B_in["x"],
        "B_w1": _B_in["w1"],
        "B_b1": _B_in["b1"],
        "B_w2": _B_in["w2"],
        "B_b2": _B_in["b2"],
    }

def reference(A_u, A_A_re, A_A_im, A_B_re, A_B_im, A_C_re, A_C_im, A_log_dt, A_Dskip, B_x, B_w1, B_b1, B_w2, B_b2):
    def _A_ref(u, A_re, A_im, B_re, B_im, C_re, C_im, log_dt, Dskip):
        Bsz, L, D = u.shape
        dt = torch.exp(log_dt)[:, None]
        A = A_re + 1j * A_im
        Bc = B_re + 1j * B_im
        Cc = C_re + 1j * C_im
        logdA = dt * A
        dB = dt * Bc
        l = (lambda x, dt: x.to(dt))(torch.arange(L), A_re.dtype)
        P = torch.exp(logdA[:, :, None] * l[None, None, :])
        K = torch.einsum("dn,dnl,dn->dl", Cc, P, dB).real
        L2 = 2 * L
        Kp = _pad(K, ((0, 0), (0, L)))
        up = (lambda x, *d: x.permute(*d))(u, 0, 2, 1)
        up = _pad(up, ((0, 0), (0, 0), (0, L)))
        Kf = (lambda x, axes=(-2,-1): torch.fft.rfft2(x.float(), dim=axes))(Kp[:, None, :], axes=(-2, -1))
        Uf = (lambda x, axes=(-2,-1): torch.fft.rfft2(x.float(), dim=axes))(up[:, :, None, :], axes=(-2, -1))
        Yf = Uf * Kf[None, :, :, :]
        y = (lambda x, s, axes=(-2,-1): torch.fft.irfft2(x, s=s, dim=axes).to(torch.bfloat16))(Yf, (1, L2), axes=(-2, -1))[:, :, 0, :L]
        y = (lambda x, *d: x.permute(*d))(y, 0, 2, 1) + u * Dskip[None, None, :]
        return y

    def _B_ref(x, w1, b1, w2, b2):
        h = torch.einsum("bsd,df->bsf", x, w1) + b1
        zero = torch.zeros_like(h)
        r = torch.where(h > zero, h, zero)
        h = r * r
        out = torch.einsum("bsf,fd->bsd", h, w2) + b2
        return out

    x = A_u
    xn = _layernorm(x, axis=-1)
    return x + _A_ref(xn, A_A_re, A_A_im, A_B_re, A_B_im, A_C_re, A_C_im, A_log_dt, A_Dskip) + _B_ref(xn, B_w1, B_b1, B_w2, B_b2)
```

```asm
; @launch grid=(256,1,1) block=(256,1,1) lds=163840
.amdgcn_target "amdgcn-amd-amdhsa--gfx950"
.text
.globl parallel_sum__ssm_conv_s4__dense_activation_squared_relu__prompt_kernel
.p2align 8
.type parallel_sum__ssm_conv_s4__dense_activation_squared_relu__prompt_kernel,@function
parallel_sum__ssm_conv_s4__dense_activation_squared_relu__prompt_kernel:
    s_cmp_ge_u32 s2, 256
    s_cbranch_scc1 END_1
    s_load_dwordx16 s[36:51], s[0:1], 0
    s_load_dwordx16 s[52:67], s[0:1], 64
    s_load_dwordx2 s[68:69], s[0:1], 128
    v_and_b32 v2, 15, v0
    s_lshr_b32 s30, s2, 3
    s_getpc_b64 s[32:33]
    s_min_u32 s31, s30, (END_1-parallel_sum__ssm_conv_s4__dense_activation_squared_relu__prompt_kernel)/1024
    s_lshl_b32 s31, s31, 10
    s_add_u32 s32, s32, s31
    s_addc_u32 s33, s33, 0
    v_lshlrev_b32 v250, 6, v2
    v_mov_b32 v251, s33
    v_add_co_u32 v250, vcc, s32, v250
    v_lshrrev_b32 v7, 6, v0
    v_and_b32_e64 v1, 63, v0
    v_addc_co_u32 v251, vcc, 0, v251, vcc
    global_load_dword v254, v[250:251], off
    v_readfirstlane_b32 s28, v7
    v_lshlrev_b32_e64 v6, 4, v1
    s_and_b32 s29, s2, 7
    s_lshl_b32 s78, s29, 5
    s_add_u32 s78, s78, s30
    s_mov_b32 s6, 0x200000
    s_mov_b32 s7, 0x20000
    s_and_b32 s31, s29, 3
    s_lshl_b32 s31, s31, 6
    s_and_b32 s32, s29, 4
    s_lshl_b32 s32, s32, 3
    s_add_u32 s31, s31, s32
    s_add_u32 s77, s31, s30
    s_lshl_b32 s77, s77, 13
    s_lshl_b32 s32, s28, 11
    s_add_u32 s77, s77, s32
    s_lshl_b32 s31, s78, 9
    s_lshl_b32 s32, s28, 7
    s_add_u32 s31, s31, s32
    v_lshl_add_u32 v22, v1, 1, s31
    s_lshl_b32 s31, s78, 2
    s_and_b32 s32, s28, 2
    s_add_u32 s31, s31, s32
    v_mov_b32 v23, s31
    s_waitcnt lgkmcnt(0)
    s_mov_b32 s4, s36
    s_and_b32 s5, s37, 0xffff
    buffer_load_dwordx4 v[8:11], v6, s[4:7], s77 offen offset:0
    buffer_load_dwordx4 v[12:15], v6, s[4:7], s77 offen offset:1024
    global_load_ushort v24, v23, s[50:51]
    global_load_ushort v25, v23, s[52:53]
    global_load_ushort v16, v22, s[38:39]
    global_load_ushort v17, v22, s[40:41]
    global_load_ushort v18, v22, s[42:43]
    global_load_ushort v19, v22, s[44:45]
    global_load_ushort v20, v22, s[46:47]
    global_load_ushort v21, v22, s[48:49]
    s_mov_b32 s31, 0xb00080
    s_load_dword s54, s[68:69], s31
    v_lshrrev_b32_e64 v3, 4, v1
    v_bfe_u32 v4, v0, 2, 2
    v_and_b32 v5, 3, v0
    s_and_b32 s31, s30, 3
    s_lshl_b32 s79, s29, 2
    s_add_u32 s79, s79, s31
    s_lshr_b32 s80, s30, 2
    s_mul_i32 s31, s31, 3
    s_mul_i32 s24, s80, 1
    s_add_u32 s24, s24, s31
    s_mul_i32 s31, s24, 37
    s_lshr_b32 s31, s31, 9
    s_mul_i32 s31, s31, 14
    s_sub_u32 s24, s24, s31
    s_mov_b32 s10, 0x1c0000
    s_mov_b32 s11, 0x20000
    s_mov_b32 s8, s56
    s_and_b32 s9, s57, 0xffff
    s_mov_b32 s14, 0x1c0000
    s_mov_b32 s15, 0x20000
    s_mov_b32 s12, s60
    s_and_b32 s13, s61, 0xffff
    s_mov_b32 s18, 0xc00000
    s_mov_b32 s19, 0x20000
    s_mov_b32 s16, s68
    s_and_b32 s17, s69, 0xffff
    s_mov_b32 s22, 0x200000
    s_mov_b32 s23, 0x20000
    s_mov_b32 s20, s64
    s_and_b32 s21, s65, 0xffff
    s_cmp_ge_u32 s30, 28
    s_cbranch_scc1 HELPER_2
    s_and_b32 s31, s29, 3
    s_lshl_b32 s31, s31, 2
    s_and_b32 s32, s30, 3
    s_add_u32 s70, s31, s32
    s_lshr_b32 s31, s29, 2
    s_mul_i32 s31, s31, 7
    s_add_u32 s71, s31, s80
    s_mul_i32 s31, s28, 57344
    s_lshl_b32 s32, s71, 8
    s_add_u32 s72, s31, s32
    v_lshlrev_b32 v36, 1, v3
    v_xor_b32_e64 v36, v36, v2
    v_mul_u32_u24 v37, 3584, v3
    v_lshl_add_u32 v28, v36, 4, v37
    v_xor_b32_e64 v36, 8, v36
    v_lshl_add_u32 v30, v36, 4, v37
    v_add_u32 v29, 13312, v28
    v_add_u32 v31, 39936, v30
    v_add_u32 v30, 26624, v30
    s_lshl_b32 s73, s70, 17
    s_lshl_b32 s31, s28, 15
    s_add_u32 s73, s73, s31
    v_lshrrev_b32 v37, 3, v1
    v_lshlrev_b32 v37, 10, v37
    v_and_b32 v36, 7, v0
    v_xor_b32_e64 v36, v36, v3
    v_lshl_add_u32 v32, v36, 4, v37
    v_xor_b32_e64 v33, 64, v32
    v_add_u32 v34, 14336, v32
    v_add_u32 v35, 21504, v33
    v_add_u32 v33, 7168, v33
    s_lshl_b32 s74, s28, 12
    s_add_u32 m0, s74, 16384
    s_nop 0
    buffer_load_dwordx4 v32, s[4:7], s73 offen offset:0 lds
    buffer_load_dwordx4 v33, s[4:7], s73 offen offset:1024 lds
    buffer_load_dwordx4 v34, s[4:7], s73 offen offset:2048 lds
    buffer_load_dwordx4 v35, s[4:7], s73 offen offset:3072 lds
    s_add_u32 s73, s73, 128
    s_add_u32 m0, s74, 0
    s_nop 0
    buffer_load_dwordx4 v28, s[8:11], s72 offen offset:0 lds
    buffer_load_dwordx4 v29, s[8:11], s72 offen offset:1024 lds
    buffer_load_dwordx4 v30, s[8:11], s72 offen offset:2048 lds
    buffer_load_dwordx4 v31, s[8:11], s72 offen offset:3072 lds
    s_add_u32 s72, s72, 229376
    s_lshl_b32 s31, s30, 8
    v_add_u32 v48, s31, v0
    s_mov_b32 s31, 0x3f803f80
    s_mul_i32 s32, s28, 2304
    s_add_u32 s32, s32, 132096
    v_add_u32 v109, s32, v6
    s_lshr_b32 s32, s77, 6
    s_add_u32 s32, s32, 0xb10000
    v_and_b32 v108, 31, v0
    v_lshrrev_b32 v110, 1, v1
    v_lshl_add_u32 v110, v108, 26, v110
    v_mov_b32 v107, 0
    s_waitcnt vmcnt(16)
    v_dot2_f32_bf16 v100, v8, s31, 0
    v_dot2_f32_bf16 v102, v8, v8, 0
    v_dot2_f32_bf16 v101, v12, s31, 0
    v_dot2_f32_bf16 v103, v12, v12, 0
    v_dot2_f32_bf16 v100, v9, s31, v100
    v_dot2_f32_bf16 v102, v9, v9, v102
    v_dot2_f32_bf16 v101, v13, s31, v101
    v_dot2_f32_bf16 v103, v13, v13, v103
    v_dot2_f32_bf16 v100, v10, s31, v100
    v_dot2_f32_bf16 v102, v10, v10, v102
    v_dot2_f32_bf16 v101, v14, s31, v101
    v_dot2_f32_bf16 v103, v14, v14, v103
    v_dot2_f32_bf16 v100, v11, s31, v100
    v_dot2_f32_bf16 v102, v11, v11, v102
    v_dot2_f32_bf16 v101, v15, s31, v101
    v_dot2_f32_bf16 v103, v15, v15, v103
    s_nop 1
    v_permlane32_swap_b32 v100, v101
    v_permlane32_swap_b32 v102, v103
    v_add_f32 v100, v100, v101
    v_add_f32 v102, v102, v103
    s_nop 1
    v_permlane16_swap_b32 v100, v102
    v_add_f32 v100, v100, v102
    v_lshlrev_b32_e64 v118, 16, v8
    v_and_b32 v119, 0xffff0000, v8
    v_add_f32_dpp v100, v100, v100 row_ror:8 row_mask:0xf bank_mask:0xf
    v_lshlrev_b32_e64 v120, 16, v9
    v_and_b32 v121, 0xffff0000, v9
    v_add_f32_dpp v100, v100, v100 row_ror:4 row_mask:0xf bank_mask:0xf
    v_lshlrev_b32_e64 v122, 16, v10
    v_and_b32 v123, 0xffff0000, v10
    v_add_f32_dpp v100, v100, v100 row_ror:2 row_mask:0xf bank_mask:0xf
    v_lshlrev_b32_e64 v124, 16, v11
    v_and_b32 v125, 0xffff0000, v11
    v_add_f32_dpp v100, v100, v100 row_ror:1 row_mask:0xf bank_mask:0xf
    v_mov_b32 v102, v100
    v_lshlrev_b32 v126, 16, v12
    v_and_b32 v127, 0xffff0000, v12
    v_permlane16_swap_b32 v100, v102
    s_add_u32 m0, s74, 49152
    s_nop 0
    buffer_load_dwordx4 v32, s[4:7], s73 offen offset:0 lds
    v_mul_f32 v101, 0x3b000000, v100
    v_mul_f32_e64 v108, v101, v101
    v_mul_f32 v105, 0x3b000000, v102
    v_sub_f32 v105, v105, v108
    v_max_f32 v105, 0, v105
    v_cvt_pk_bf16_f32 v108, v101, v105
    v_lshlrev_b32_e64 v101, 16, v108
    v_and_b32 v105, 0xffff0000, v108
    v_add_f32 v105, 0x3727c5ac, v105
    v_cvt_pk_bf16_f32 v105, v105, v105
    v_lshlrev_b32 v105, 16, v105
    v_sqrt_f32_e64 v105, v105
    s_nop 0
    v_cvt_pk_bf16_f32 v105, v105, v105
    v_lshlrev_b32 v105, 16, v105
    v_rcp_f32 v106, v105
    buffer_load_dwordx4 v33, s[4:7], s73 offen offset:1024 lds
    v_lshlrev_b32_e64 v128, 16, v13
    v_and_b32 v129, 0xffff0000, v13
    v_lshlrev_b32_e64 v130, 16, v14
    v_and_b32 v131, 0xffff0000, v14
    v_lshlrev_b32_e64 v132, 16, v15
    v_and_b32 v133, 0xffff0000, v15
    v_mul_f32_e64 v108, v101, v106
    v_cvt_pk_bf16_f32 v104, -v101, -v101
    v_lshrrev_b32_e64 v105, 16, v105
    v_readlane_b32 s34, v106, 0
    v_readlane_b32 s35, v108, 0
    v_readlane_b32 vcc_lo, v106, 32
    v_readlane_b32 vcc_hi, v108, 32
    buffer_store_dwordx4 v[104:107], v110, s[16:19], s32 offen sc1
    v_pk_fma_f32 v[118:119], v[118:119], s[34:35], s[34:35] op_sel:[0,0,1] op_sel_hi:[1,0,1] neg_lo:[0,0,1] neg_hi:[0,0,1]
    v_pk_fma_f32 v[120:121], v[120:121], s[34:35], s[34:35] op_sel:[0,0,1] op_sel_hi:[1,0,1] neg_lo:[0,0,1] neg_hi:[0,0,1]
    v_pk_fma_f32 v[122:123], v[122:123], s[34:35], s[34:35] op_sel:[0,0,1] op_sel_hi:[1,0,1] neg_lo:[0,0,1] neg_hi:[0,0,1]
    v_pk_fma_f32 v[124:125], v[124:125], s[34:35], s[34:35] op_sel:[0,0,1] op_sel_hi:[1,0,1] neg_lo:[0,0,1] neg_hi:[0,0,1]
    v_cvt_pk_bf16_f32 v8, v118, v119
    v_cvt_pk_bf16_f32 v9, v120, v121
    v_cvt_pk_bf16_f32 v10, v122, v123
    v_cvt_pk_bf16_f32 v11, v124, v125
    ds_write_b128 v109, v[8:11] offset:0
    buffer_load_dwordx4 v34, s[4:7], s73 offen offset:2048 lds
    v_pk_fma_f32 v[126:127], v[126:127], vcc, vcc op_sel:[0,0,1] op_sel_hi:[1,0,1] neg_lo:[0,0,1] neg_hi:[0,0,1]
    v_pk_fma_f32 v[128:129], v[128:129], vcc, vcc op_sel:[0,0,1] op_sel_hi:[1,0,1] neg_lo:[0,0,1] neg_hi:[0,0,1]
    v_pk_fma_f32 v[130:131], v[130:131], vcc, vcc op_sel:[0,0,1] op_sel_hi:[1,0,1] neg_lo:[0,0,1] neg_hi:[0,0,1]
    v_pk_fma_f32 v[132:133], v[132:133], vcc, vcc op_sel:[0,0,1] op_sel_hi:[1,0,1] neg_lo:[0,0,1] neg_hi:[0,0,1]
    v_cvt_pk_bf16_f32 v12, v126, v127
    v_cvt_pk_bf16_f32 v13, v128, v129
    v_cvt_pk_bf16_f32 v14, v130, v131
    v_cvt_pk_bf16_f32 v15, v132, v133
    ds_write_b128 v109, v[12:15] offset:1152
    buffer_load_dwordx4 v35, s[4:7], s73 offen offset:3072 lds
    s_add_u32 s73, s73, 128
    s_mul_i32 s35, s28, 4608
    s_add_u32 s35, s35, 141312
    v_lshl_add_u32 v51, v1, 2, s35
    v_mul_u32_u24 v52, 288, v2
    v_lshl_add_u32 v52, v3, 4, v52
    v_add_u32 v52, s35, v52
    v_add_u32 v50, s35, v6
    v_add_u32_e64 v54, 0, v51
    v_add_u32 v55, 1152, v51
    v_add_u32 v56, 2304, v51
    v_add_u32 v57, 3456, v51
    s_mov_b32 s31, 0x3fb8aa3b
    s_mov_b32 s32, 0x32a57060
    s_waitcnt vmcnt(13)
    v_lshlrev_b32 v24, 16, v24
    v_lshlrev_b32 v25, 16, v25
    v_mul_f32 v100, s31, v24
    v_fma_f32 v101, v24, s31, -v100
    v_exp_f32_e64 v100, v100
    v_fma_f32 v101, v24, s32, v101
    v_lshlrev_b32 v16, 16, v16
    v_lshlrev_b32 v17, 16, v17
    v_lshlrev_b32 v18, 16, v18
    v_lshlrev_b32 v19, 16, v19
    v_lshlrev_b32 v20, 16, v20
    v_lshlrev_b32 v21, 16, v21
    v_mul_f32 v101, 0x3f317218, v101
    v_fma_f32 v100, v100, v101, v100
    v_cvt_pk_bf16_f32 v100, v100, v100
    v_lshlrev_b32_e64 v24, 16, v100
    v_pk_mul_f32 v[16:17], v[16:17], v[24:25] op_sel_hi:[1,0]
    v_pk_mul_f32 v[18:19], v[18:19], v[24:25] op_sel_hi:[1,0]
    v_mul_f32 v16, s31, v16
    v_mul_f32 v17, 0.15915494, v17
    v_mul_f32 v58, 1.0, v16
    v_mul_f32 v59, 1.0, v17
    v_mul_f32 v60, 0x41000000, v16
    v_mul_f32 v61, 0x41000000, v17
    v_mul_f32 v62, 0x43800000, v16
    v_mul_f32 v63, 0x43800000, v17
    v_fract_f32 v59, v59
    v_exp_f32 v58, v58
    v_fract_f32 v61, v61
    v_exp_f32 v60, v60
    v_fract_f32 v63, v63
    v_exp_f32 v62, v62
    v_cos_f32 v108, v59
    v_sin_f32 v109, v59
    v_cos_f32 v70, v61
    v_sin_f32 v71, v61
    v_cos_f32 v118, v63
    v_sin_f32 v119, v63
    v_pk_mul_f32 v[108:109], v[108:109], v[58:59] op_sel_hi:[1,0]
    v_pk_mul_f32 v[70:71], v[70:71], v[60:61] op_sel_hi:[1,0]
    v_pk_mul_f32 v[118:119], v[118:119], v[62:63] op_sel_hi:[1,0]
    s_lshl_b32 s34, s28, 8
    s_add_u32 s34, s34, 132096
    s_nop 0
    v_mul_u32_u24 v120, 1152, v4
    v_lshl_add_u32 v120, v3, 5, v120
    v_lshl_add_u32 v120, v5, 3, v120
    v_add_u32_e64 v120, s34, v120
    s_waitcnt lgkmcnt(0)
    s_barrier
    s_add_u32 s54, s54, 0x9e3779b9
    ds_read_b64_tr_b16 v[8:9], v120 offset:0
    ds_read_b64_tr_b16 v[10:11], v120 offset:4608
    ds_read_b64_tr_b16 v[12:13], v120 offset:128
    ds_read_b64_tr_b16 v[14:15], v120 offset:4736
    s_add_u32 m0, s74, 32768
    s_nop 0
    buffer_load_dwordx4 v28, s[8:11], s72 offen offset:0 lds
    s_nop 0
    v_mov_b32 v102, 0x3f80
    ds_write_b32 v51, v102
    v_pk_mul_f32 v[58:59], v[108:109], v[108:109] op_sel_hi:[0,1]
    v_pk_mul_f32 v[60:61], v[118:119], v[118:119] op_sel_hi:[0,1]
    v_pk_fma_f32 v[114:115], v[108:109], v[108:109], v[58:59] op_sel:[1,1,0] op_sel_hi:[1,0,1] neg_lo:[0,1,0]
    v_pk_fma_f32 v[116:117], v[118:119], v[118:119], v[60:61] op_sel:[1,1,0] op_sel_hi:[1,0,1] neg_lo:[0,1,0]
    v_cvt_pk_bf16_f32 v53, v114, v115
    v_cvt_pk_bf16_f32 v66, v116, v117
    v_cvt_pk_bf16_f32 v67, v108, v109
    v_cvt_pk_bf16_f32 v68, v118, v119
    ds_write2_b32 v54, v53, v67 offset0:144 offset1:72
    ds_write_b32 v51, v66 offset:2304
    ds_write_b32 v51, v68 offset:1152
    s_add_u32 s77, s77, 0x700000
    s_waitcnt lgkmcnt(4)
    buffer_store_dwordx4 v[8:11], v6, s[16:19], s77 offen offset:0 sc1
    buffer_store_dwordx4 v[12:15], v6, s[16:19], s77 offen offset:1024 sc1
    buffer_load_dwordx4 v29, s[8:11], s72 offen offset:1024 lds
    s_nop 0
    v_pk_mul_f32 v[58:59], v[114:115], v[114:115] op_sel_hi:[0,1]
    v_pk_mul_f32 v[60:61], v[116:117], v[116:117] op_sel_hi:[0,1]
    v_pk_mul_f32 v[62:63], v[114:115], v[108:109] op_sel_hi:[0,1]
    v_pk_mul_f32 v[64:65], v[118:119], v[114:115] op_sel_hi:[0,1]
    v_pk_fma_f32 v[120:121], v[114:115], v[114:115], v[58:59] op_sel:[1,1,0] op_sel_hi:[1,0,1] neg_lo:[0,1,0]
    v_pk_fma_f32 v[122:123], v[116:117], v[116:117], v[60:61] op_sel:[1,1,0] op_sel_hi:[1,0,1] neg_lo:[0,1,0]
    v_pk_fma_f32 v[124:125], v[114:115], v[108:109], v[62:63] op_sel:[1,1,0] op_sel_hi:[1,0,1] neg_lo:[0,1,0]
    v_pk_fma_f32 v[104:105], v[118:119], v[114:115], v[64:65] op_sel:[1,1,0] op_sel_hi:[1,0,1] neg_lo:[0,1,0]
    v_cvt_pk_bf16_f32 v66, v122, v123
    v_cvt_pk_bf16_f32 v67, v124, v125
    v_cvt_pk_bf16_f32 v68, v104, v105
    ds_write_b32 v51, v66 offset:3456
    ds_write_b32 v51, v67 offset:864
    ds_write_b32 v51, v68 offset:1440
    s_lshl_b32 s33, s2, 2
    s_add_u32 s33, s33, s28
    s_mul_i32 s33, s33, 896
    s_add_u32 s33, s33, 917504
    v_min_u32 v49, 6, v1
    v_lshlrev_b32 v49, 7, v49
    buffer_load_dword v255, v49, s[8:11], s33 offen
    v_pk_mul_f32 v[58:59], v[120:121], v[114:115] op_sel_hi:[0,1]
    v_pk_mul_f32 v[60:61], v[122:123], v[118:119] op_sel_hi:[0,1]
    v_pk_mul_f32 v[62:63], v[118:119], v[120:121] op_sel_hi:[0,1]
    v_pk_mul_f32 v[64:65], v[116:117], v[120:121] op_sel_hi:[0,1]
    v_pk_fma_f32 v[126:127], v[120:121], v[114:115], v[58:59] op_sel:[1,1,0] op_sel_hi:[1,0,1] neg_lo:[0,1,0]
    v_pk_fma_f32 v[128:129], v[122:123], v[118:119], v[60:61] op_sel:[1,1,0] op_sel_hi:[1,0,1] neg_lo:[0,1,0]
    v_pk_fma_f32 v[104:105], v[118:119], v[120:121], v[62:63] op_sel:[1,1,0] op_sel_hi:[1,0,1] neg_lo:[0,1,0]
    v_pk_fma_f32 v[106:107], v[116:117], v[120:121], v[64:65] op_sel:[1,1,0] op_sel_hi:[1,0,1] neg_lo:[0,1,0]
    v_cvt_pk_bf16_f32 v66, v128, v129
    v_cvt_pk_bf16_f32 v67, v104, v105
    v_cvt_pk_bf16_f32 v68, v106, v107
    ds_write_b32 v51, v66 offset:4032
    ds_write_b32 v51, v67 offset:1728
    ds_write_b32 v51, v68 offset:2592
    s_lshl_b32 s33, s2, 2
    s_add_u32 s33, s33, s28
    s_mul_i32 s33, s33, 1792
    v_min_u32 v49, 13, v1
    v_lshlrev_b32 v49, 7, v49
    buffer_load_dword v255, v49, s[12:15], s33 offen
    v_pk_mul_f32 v[58:59], v[118:119], v[126:127] op_sel_hi:[0,1]
    v_pk_mul_f32 v[60:61], v[116:117], v[70:71] op_sel_hi:[0,1]
    v_pk_mul_f32 v[62:63], v[122:123], v[70:71] op_sel_hi:[0,1]
    v_pk_mul_f32 v[64:65], v[128:129], v[70:71] op_sel_hi:[0,1]
    v_pk_fma_f32 v[104:105], v[118:119], v[126:127], v[58:59] op_sel:[1,1,0] op_sel_hi:[1,0,1] neg_lo:[0,1,0]
    v_pk_fma_f32 v[106:107], v[116:117], v[70:71], v[60:61] op_sel:[1,1,0] op_sel_hi:[1,0,1] neg_lo:[0,1,0]
    v_pk_fma_f32 v[110:111], v[122:123], v[70:71], v[62:63] op_sel:[1,1,0] op_sel_hi:[1,0,1] neg_lo:[0,1,0]
    v_pk_fma_f32 v[112:113], v[128:129], v[70:71], v[64:65] op_sel:[1,1,0] op_sel_hi:[1,0,1] neg_lo:[0,1,0]
    v_cvt_pk_bf16_f32 v53, v104, v105
    v_cvt_pk_bf16_f32 v66, v106, v107
    v_cvt_pk_bf16_f32 v67, v110, v111
    v_cvt_pk_bf16_f32 v68, v112, v113
    ds_write_b32 v51, v53 offset:2016
    ds_write_b32 v51, v66 offset:2880
    ds_write2_b32 v57, v67, v68 offset0:72 offset1:216
    s_lshl_b32 s33, s80, 7
    v_mov_b32 v49, s33
    global_load_dword v255, v49, s[62:63]
    ds_read_b128 a[0:3], v52 offset:0
    ds_read_b128 a[4:7], v52 offset:64
    ds_read_b128 a[8:11], v52 offset:128
    ds_read_b128 a[12:15], v52 offset:192
    v_pk_mul_f32 v[58:59], v[116:117], v[118:119] op_sel_hi:[0,1]
    v_pk_mul_f32 v[60:61], v[122:123], v[116:117] op_sel_hi:[0,1]
    v_pk_fma_f32 v[130:131], v[116:117], v[118:119], v[58:59] op_sel:[1,1,0] op_sel_hi:[1,0,1] neg_lo:[0,1,0]
    v_pk_fma_f32 v[132:133], v[122:123], v[116:117], v[60:61] op_sel:[1,1,0] op_sel_hi:[1,0,1] neg_lo:[0,1,0]
    v_cvt_pk_bf16_f32 v53, v130, v131
    v_cvt_pk_bf16_f32 v66, v132, v133
    v_cvt_pk_bf16_f32 v67, v120, v121
    v_cvt_pk_bf16_f32 v68, v126, v127
    ds_write_b32 v51, v53 offset:2304
    ds_write_b32 v51, v66 offset:3456
    ds_write2_b32 v54, v67, v68 offset0:0 offset1:144
    v_pk_mul_f32 v[58:59], v[122:123], v[130:131] op_sel_hi:[0,1]
    v_pk_mul_f32 v[60:61], v[120:121], v[108:109] op_sel_hi:[0,1]
    v_pk_mul_f32 v[62:63], v[120:121], v[124:125] op_sel_hi:[0,1]
    v_pk_mul_f32 v[64:65], v[118:119], v[70:71] op_sel_hi:[0,1]
    v_pk_fma_f32 v[134:135], v[122:123], v[130:131], v[58:59] op_sel:[1,1,0] op_sel_hi:[1,0,1] neg_lo:[0,1,0]
    v_pk_fma_f32 v[106:107], v[120:121], v[108:109], v[60:61] op_sel:[1,1,0] op_sel_hi:[1,0,1] neg_lo:[0,1,0]
    v_pk_fma_f32 v[110:111], v[120:121], v[124:125], v[62:63] op_sel:[1,1,0] op_sel_hi:[1,0,1] neg_lo:[0,1,0]
    v_pk_fma_f32 v[112:113], v[118:119], v[70:71], v[64:65] op_sel:[1,1,0] op_sel_hi:[1,0,1] neg_lo:[0,1,0]
    v_cvt_pk_bf16_f32 v53, v134, v135
    v_cvt_pk_bf16_f32 v66, v106, v107
    v_cvt_pk_bf16_f32 v67, v110, v111
    v_cvt_pk_bf16_f32 v68, v112, v113
    ds_write_b32 v51, v53 offset:4032
    ds_write2_b32 v54, v66, v67 offset0:72 offset1:216
    ds_write_b32 v51, v68 offset:1152
    buffer_load_dwordx4 v30, s[8:11], s72 offen offset:2048 lds
    v_pk_mul_f32 v[58:59], v[130:131], v[120:121] op_sel_hi:[0,1]
    v_pk_mul_f32 v[60:61], v[130:131], v[70:71] op_sel_hi:[0,1]
    v_pk_mul_f32 v[62:63], v[132:133], v[70:71] op_sel_hi:[0,1]
    v_pk_mul_f32 v[64:65], v[134:135], v[70:71] op_sel_hi:[0,1]
    v_pk_fma_f32 v[104:105], v[130:131], v[120:121], v[58:59] op_sel:[1,1,0] op_sel_hi:[1,0,1] neg_lo:[0,1,0]
    v_pk_fma_f32 v[106:107], v[130:131], v[70:71], v[60:61] op_sel:[1,1,0] op_sel_hi:[1,0,1] neg_lo:[0,1,0]
    v_pk_fma_f32 v[110:111], v[132:133], v[70:71], v[62:63] op_sel:[1,1,0] op_sel_hi:[1,0,1] neg_lo:[0,1,0]
    v_pk_fma_f32 v[112:113], v[134:135], v[70:71], v[64:65] op_sel:[1,1,0] op_sel_hi:[1,0,1] neg_lo:[0,1,0]
    v_cvt_pk_bf16_f32 v53, v104, v105
    v_cvt_pk_bf16_f32 v66, v106, v107
    v_cvt_pk_bf16_f32 v67, v110, v111
    v_cvt_pk_bf16_f32 v68, v112, v113
    ds_write2_b32 v56, v53, v66 offset0:72 offset1:144
    ds_write2_b32 v57, v67, v68 offset0:72 offset1:216
    buffer_load_dwordx4 v31, s[8:11], s72 offen offset:3072 lds
    s_add_u32 s72, s72, 229376
    ds_read_b128 a[16:19], v52 offset:0
    ds_read_b128 a[20:23], v52 offset:64
    ds_read_b128 a[24:27], v52 offset:128
    ds_read_b128 a[28:31], v52 offset:192
    v_pk_mul_f32 v[58:59], v[20:21], v[18:19] op_sel_hi:[0,1]
    v_pk_mul_f32 v[60:61], v[70:71], v[70:71] op_sel_hi:[0,1]
    v_pk_fma_f32 v[72:73], v[20:21], v[18:19], v[58:59] op_sel:[1,1,0] op_sel_hi:[1,0,1] neg_lo:[0,1,0]
    v_pk_fma_f32 v[48:49], v[70:71], v[70:71], v[60:61] op_sel:[1,1,0] op_sel_hi:[1,0,1] neg_lo:[0,1,0]
    v_cvt_pk_bf16_f32 v53, v72, -v73
    ds_write_b32 v51, v53 offset:0
    s_add_u32 m0, s74, 81920
    s_nop 0
    buffer_load_dwordx4 v32, s[4:7], s73 offen offset:0 lds
    s_nop 0
    v_pk_mul_f32 v[58:59], v[72:73], v[70:71] op_sel_hi:[0,1]
    v_pk_mul_f32 v[60:61], v[48:49], v[48:49] op_sel_hi:[0,1]
    v_pk_mul_f32 v[62:63], v[72:73], v[48:49] op_sel_hi:[0,1]
    v_pk_fma_f32 v[74:75], v[72:73], v[70:71], v[58:59] op_sel:[1,1,0] op_sel_hi:[1,0,1] neg_lo:[0,1,0]
    v_pk_fma_f32 v[80:81], v[48:49], v[48:49], v[60:61] op_sel:[1,1,0] op_sel_hi:[1,0,1] neg_lo:[0,1,0]
    v_pk_fma_f32 v[76:77], v[72:73], v[48:49], v[62:63] op_sel:[1,1,0] op_sel_hi:[1,0,1] neg_lo:[0,1,0]
    v_cvt_pk_bf16_f32 v53, v74, -v75
    v_cvt_pk_bf16_f32 v67, v76, -v77
    ds_write2_b32 v54, v53, v67 offset0:72 offset1:144
    buffer_load_dwordx4 v33, s[4:7], s73 offen offset:1024 lds
    v_pk_mul_f32 v[58:59], v[74:75], v[48:49] op_sel_hi:[0,1]
    v_pk_mul_f32 v[60:61], v[72:73], v[80:81] op_sel_hi:[0,1]
    v_pk_fma_f32 v[78:79], v[74:75], v[48:49], v[58:59] op_sel:[1,1,0] op_sel_hi:[1,0,1] neg_lo:[0,1,0]
    v_pk_fma_f32 v[72:73], v[72:73], v[80:81], v[60:61] op_sel:[1,1,0] op_sel_hi:[1,0,1] neg_lo:[0,1,0]
    v_cvt_pk_bf16_f32 v53, v78, -v79
    v_cvt_pk_bf16_f32 v66, v72, -v73
    ds_write_b32 v51, v53 offset:864
    ds_write_b32 v51, v66 offset:1152
    buffer_load_dwordx4 v34, s[4:7], s73 offen offset:2048 lds
    v_pk_mul_f32 v[58:59], v[74:75], v[80:81] op_sel_hi:[0,1]
    v_pk_mul_f32 v[60:61], v[76:77], v[80:81] op_sel_hi:[0,1]
    v_pk_mul_f32 v[62:63], v[78:79], v[80:81] op_sel_hi:[0,1]
    v_pk_fma_f32 v[74:75], v[74:75], v[80:81], v[58:59] op_sel:[1,1,0] op_sel_hi:[1,0,1] neg_lo:[0,1,0]
    v_pk_fma_f32 v[76:77], v[76:77], v[80:81], v[60:61] op_sel:[1,1,0] op_sel_hi:[1,0,1] neg_lo:[0,1,0]
    v_pk_fma_f32 v[78:79], v[78:79], v[80:81], v[62:63] op_sel:[1,1,0] op_sel_hi:[1,0,1] neg_lo:[0,1,0]
    v_cvt_pk_bf16_f32 v53, v74, -v75
    v_cvt_pk_bf16_f32 v66, v76, -v77
    v_cvt_pk_bf16_f32 v67, v78, -v79
    ds_write2_b32 v55, v53, v66 offset0:72 offset1:144
    ds_write_b32 v51, v67 offset:2016
    buffer_load_dwordx4 v35, s[4:7], s73 offen offset:3072 lds
    s_add_u32 s73, s73, 128
    v_pk_mul_f32 v[58:59], v[72:73], v[80:81] op_sel_hi:[0,1]
    v_pk_mul_f32 v[60:61], v[74:75], v[80:81] op_sel_hi:[0,1]
    v_pk_mul_f32 v[62:63], v[76:77], v[80:81] op_sel_hi:[0,1]
    v_pk_mul_f32 v[64:65], v[78:79], v[80:81] op_sel_hi:[0,1]
    v_pk_fma_f32 v[72:73], v[72:73], v[80:81], v[58:59] op_sel:[1,1,0] op_sel_hi:[1,0,1] neg_lo:[0,1,0]
    v_pk_fma_f32 v[74:75], v[74:75], v[80:81], v[60:61] op_sel:[1,1,0] op_sel_hi:[1,0,1] neg_lo:[0,1,0]
    v_pk_fma_f32 v[76:77], v[76:77], v[80:81], v[62:63] op_sel:[1,1,0] op_sel_hi:[1,0,1] neg_lo:[0,1,0]
    v_pk_fma_f32 v[78:79], v[78:79], v[80:81], v[64:65] op_sel:[1,1,0] op_sel_hi:[1,0,1] neg_lo:[0,1,0]
    v_cvt_pk_bf16_f32 v53, v72, -v73
    v_cvt_pk_bf16_f32 v66, v74, -v75
    v_cvt_pk_bf16_f32 v67, v76, -v77
    v_cvt_pk_bf16_f32 v68, v78, -v79
    ds_write2_b32 v56, v53, v66 offset0:0 offset1:72
    ds_write2_b32 v56, v67, v68 offset0:144 offset1:216
    s_add_u32 m0, s74, 65536
    s_nop 0
    buffer_load_dwordx4 v28, s[8:11], s72 offen offset:0 lds
    s_nop 0
    v_pk_mul_f32 v[58:59], v[72:73], v[80:81] op_sel_hi:[0,1]
    v_pk_mul_f32 v[60:61], v[74:75], v[80:81] op_sel_hi:[0,1]
    v_pk_mul_f32 v[62:63], v[76:77], v[80:81] op_sel_hi:[0,1]
    v_pk_mul_f32 v[64:65], v[78:79], v[80:81] op_sel_hi:[0,1]
    v_pk_fma_f32 v[72:73], v[72:73], v[80:81], v[58:59] op_sel:[1,1,0] op_sel_hi:[1,0,1] neg_lo:[0,1,0]
    v_pk_fma_f32 v[74:75], v[74:75], v[80:81], v[60:61] op_sel:[1,1,0] op_sel_hi:[1,0,1] neg_lo:[0,1,0]
    v_pk_fma_f32 v[76:77], v[76:77], v[80:81], v[62:63] op_sel:[1,1,0] op_sel_hi:[1,0,1] neg_lo:[0,1,0]
    v_pk_fma_f32 v[78:79], v[78:79], v[80:81], v[64:65] op_sel:[1,1,0] op_sel_hi:[1,0,1] neg_lo:[0,1,0]
    v_cvt_pk_bf16_f32 v53, v72, -v73
    v_cvt_pk_bf16_f32 v66, v74, -v75
    v_cvt_pk_bf16_f32 v67, v76, -v77
    v_cvt_pk_bf16_f32 v68, v78, -v79
    ds_write2_b32 v57, v53, v66 offset0:0 offset1:72
    ds_write2_b32 v57, v67, v68 offset0:144 offset1:216
    buffer_load_dwordx4 v29, s[8:11], s72 offen offset:1024 lds
    ds_read_b128 a[32:35], v52 offset:0
    ds_read_b128 a[36:39], v52 offset:64
    ds_read_b128 a[40:43], v52 offset:128
    ds_read_b128 a[44:47], v52 offset:192
    v_pk_mul_f32 v[58:59], v[72:73], v[80:81] op_sel_hi:[0,1]
    v_pk_mul_f32 v[60:61], v[74:75], v[80:81] op_sel_hi:[0,1]
    v_pk_mul_f32 v[62:63], v[76:77], v[80:81] op_sel_hi:[0,1]
    v_pk_mul_f32 v[64:65], v[78:79], v[80:81] op_sel_hi:[0,1]
    v_pk_fma_f32 v[72:73], v[72:73], v[80:81], v[58:59] op_sel:[1,1,0] op_sel_hi:[1,0,1] neg_lo:[0,1,0]
    v_pk_fma_f32 v[74:75], v[74:75], v[80:81], v[60:61] op_sel:[1,1,0] op_sel_hi:[1,0,1] neg_lo:[0,1,0]
    v_pk_fma_f32 v[76:77], v[76:77], v[80:81], v[62:63] op_sel:[1,1,0] op_sel_hi:[1,0,1] neg_lo:[0,1,0]
    v_pk_fma_f32 v[78:79], v[78:79], v[80:81], v[64:65] op_sel:[1,1,0] op_sel_hi:[1,0,1] neg_lo:[0,1,0]
    v_cvt_pk_bf16_f32 v53, v72, -v73
    v_cvt_pk_bf16_f32 v66, v74, -v75
    v_cvt_pk_bf16_f32 v67, v76, -v77
    v_cvt_pk_bf16_f32 v68, v78, -v79
    ds_write2_b32 v54, v53, v66 offset0:0 offset1:72
    ds_write2_b32 v54, v67, v68 offset0:144 offset1:216
    buffer_load_dwordx4 v30, s[8:11], s72 offen offset:2048 lds
    v_pk_mul_f32 v[58:59], v[72:73], v[80:81] op_sel_hi:[0,1]
    v_pk_mul_f32 v[60:61], v[74:75], v[80:81] op_sel_hi:[0,1]
    v_pk_mul_f32 v[62:63], v[76:77], v[80:81] op_sel_hi:[0,1]
    v_pk_mul_f32 v[64:65], v[78:79], v[80:81] op_sel_hi:[0,1]
    v_pk_fma_f32 v[72:73], v[72:73], v[80:81], v[58:59] op_sel:[1,1,0] op_sel_hi:[1,0,1] neg_lo:[0,1,0]
    v_pk_fma_f32 v[74:75], v[74:75], v[80:81], v[60:61] op_sel:[1,1,0] op_sel_hi:[1,0,1] neg_lo:[0,1,0]
    v_pk_fma_f32 v[76:77], v[76:77], v[80:81], v[62:63] op_sel:[1,1,0] op_sel_hi:[1,0,1] neg_lo:[0,1,0]
    v_pk_fma_f32 v[78:79], v[78:79], v[80:81], v[64:65] op_sel:[1,1,0] op_sel_hi:[1,0,1] neg_lo:[0,1,0]
    v_cvt_pk_bf16_f32 v53, v72, -v73
    v_cvt_pk_bf16_f32 v66, v74, -v75
    v_cvt_pk_bf16_f32 v67, v76, -v77
    v_cvt_pk_bf16_f32 v68, v78, -v79
    ds_write2_b32 v55, v53, v66 offset0:0 offset1:72
    ds_write2_b32 v55, v67, v68 offset0:144 offset1:216
    buffer_load_dwordx4 v31, s[8:11], s72 offen offset:3072 lds
    s_add_u32 s72, s72, 229376
    s_waitcnt lgkmcnt(4)
    v_mfma_f32_16x16x32_bf16 a[64:67], a[0:3], a[32:35], 0
    v_mfma_f32_16x16x32_bf16 a[68:71], a[16:19], a[32:35], 0
    s_nop 0
    v_pk_mul_f32 v[58:59], v[72:73], v[80:81] op_sel_hi:[0,1]
    v_pk_mul_f32 v[60:61], v[74:75], v[80:81] op_sel_hi:[0,1]
    v_pk_mul_f32 v[62:63], v[76:77], v[80:81] op_sel_hi:[0,1]
    v_pk_mul_f32 v[64:65], v[78:79], v[80:81] op_sel_hi:[0,1]
    v_pk_fma_f32 v[72:73], v[72:73], v[80:81], v[58:59] op_sel:[1,1,0] op_sel_hi:[1,0,1] neg_lo:[0,1,0]
    v_pk_fma_f32 v[74:75], v[74:75], v[80:81], v[60:61] op_sel:[1,1,0] op_sel_hi:[1,0,1] neg_lo:[0,1,0]
    v_pk_fma_f32 v[76:77], v[76:77], v[80:81], v[62:63] op_sel:[1,1,0] op_sel_hi:[1,0,1] neg_lo:[0,1,0]
    v_pk_fma_f32 v[78:79], v[78:79], v[80:81], v[64:65] op_sel:[1,1,0] op_sel_hi:[1,0,1] neg_lo:[0,1,0]
    v_cvt_pk_bf16_f32 v53, v72, -v73
    v_cvt_pk_bf16_f32 v66, v74, -v75
    v_cvt_pk_bf16_f32 v67, v76, -v77
    v_cvt_pk_bf16_f32 v68, v78, -v79
    ds_write2_b32 v56, v53, v66 offset0:0 offset1:72
    ds_write2_b32 v56, v67, v68 offset0:144 offset1:216
    s_add_u32 m0, s74, 114688
    s_nop 0
    buffer_load_dwordx4 v32, s[4:7], s73 offen offset:0 lds
    v_mfma_f32_16x16x32_bf16 a[64:67], a[4:7], a[36:39], a[64:67]
    v_mfma_f32_16x16x32_bf16 a[68:71], a[20:23], a[36:39], a[68:71]
    s_nop 0
    v_pk_mul_f32 v[58:59], v[72:73], v[80:81] op_sel_hi:[0,1]
    v_pk_mul_f32 v[60:61], v[74:75], v[80:81] op_sel_hi:[0,1]
    v_pk_mul_f32 v[62:63], v[76:77], v[80:81] op_sel_hi:[0,1]
    v_pk_mul_f32 v[64:65], v[78:79], v[80:81] op_sel_hi:[0,1]
    v_pk_fma_f32 v[72:73], v[72:73], v[80:81], v[58:59] op_sel:[1,1,0] op_sel_hi:[1,0,1] neg_lo:[0,1,0]
    v_pk_fma_f32 v[74:75], v[74:75], v[80:81], v[60:61] op_sel:[1,1,0] op_sel_hi:[1,0,1] neg_lo:[0,1,0]
    v_pk_fma_f32 v[76:77], v[76:77], v[80:81], v[62:63] op_sel:[1,1,0] op_sel_hi:[1,0,1] neg_lo:[0,1,0]
    v_pk_fma_f32 v[78:79], v[78:79], v[80:81], v[64:65] op_sel:[1,1,0] op_sel_hi:[1,0,1] neg_lo:[0,1,0]
    v_cvt_pk_bf16_f32 v53, v72, -v73
    v_cvt_pk_bf16_f32 v66, v74, -v75
    v_cvt_pk_bf16_f32 v67, v76, -v77
    v_cvt_pk_bf16_f32 v68, v78, -v79
    ds_write2_b32 v57, v53, v66 offset0:0 offset1:72
    ds_write2_b32 v57, v67, v68 offset0:144 offset1:216
    buffer_load_dwordx4 v33, s[4:7], s73 offen offset:1024 lds
    v_mfma_f32_16x16x32_bf16 a[64:67], a[8:11], a[40:43], a[64:67]
    v_mfma_f32_16x16x32_bf16 a[68:71], a[24:27], a[40:43], a[68:71]
    ds_read_b128 a[48:51], v52 offset:0
    ds_read_b128 a[52:55], v52 offset:64
    ds_read_b128 a[56:59], v52 offset:128
    ds_read_b128 a[60:63], v52 offset:192
    v_mfma_f32_16x16x32_bf16 a[64:67], a[12:15], a[44:47], a[64:67]
    v_mfma_f32_16x16x32_bf16 a[68:71], a[28:31], a[44:47], a[68:71]
    s_waitcnt lgkmcnt(0)
    v_mfma_f32_16x16x32_bf16 a[72:75], a[0:3], a[48:51], 0
    v_mfma_f32_16x16x32_bf16 a[76:79], a[16:19], a[48:51], 0
    v_mfma_f32_16x16x32_bf16 a[72:75], a[4:7], a[52:55], a[72:75]
    v_mfma_f32_16x16x32_bf16 a[76:79], a[20:23], a[52:55], a[76:79]
    v_mfma_f32_16x16x32_bf16 a[72:75], a[8:11], a[56:59], a[72:75]
    v_mfma_f32_16x16x32_bf16 a[76:79], a[24:27], a[56:59], a[76:79]
    v_mfma_f32_16x16x32_bf16 a[72:75], a[12:15], a[60:63], a[72:75]
    v_mfma_f32_16x16x32_bf16 a[76:79], a[28:31], a[60:63], a[76:79]
    ds_write_b128 v50, a[64:67] offset:0
    ds_write_b128 v50, a[68:71] offset:1024
    s_nop 4
    ds_write_b128 v50, a[72:75] offset:2048
    ds_write_b128 v50, a[76:79] offset:3072
    buffer_load_dwordx4 v34, s[4:7], s73 offen offset:2048 lds
    buffer_load_dwordx4 v35, s[4:7], s73 offen offset:3072 lds
    s_add_u32 s73, s73, 128
    s_add_u32 m0, s74, 98304
    s_nop 0
    buffer_load_dwordx4 v28, s[8:11], s72 offen offset:0 lds
    buffer_load_dwordx4 v29, s[8:11], s72 offen offset:1024 lds
    buffer_load_dwordx4 v30, s[8:11], s72 offen offset:2048 lds
    buffer_load_dwordx4 v31, s[8:11], s72 offen offset:3072 lds
    s_add_u32 s72, s72, 229376
    s_nop 0
    v_lshl_add_u32 v36, v3, 3, v4
    v_lshlrev_b32_e64 v36, 8, v36
    v_lshl_add_u32 v36, v5, 3, v36
    v_and_b32_e64 v37, 1, v3
    v_lshl_add_u32 v37, v37, 2, v4
    s_and_b32 s31, s28, 2
    s_lshl_b32 s31, s31, 1
    v_xor_b32 v37, s31, v37
    v_xor_b32 v38, 0, v37
    v_lshl_add_u32 v38, v38, 5, v36
    v_xor_b32_e64 v39, 1, v37
    v_lshl_add_u32 v39, v39, 5, v36
    v_xor_b32_e64 v40, 2, v37
    v_lshl_add_u32 v40, v40, 5, v36
    v_xor_b32_e64 v41, 3, v37
    v_lshl_add_u32 v41, v41, 5, v36
    s_and_b32 s31, s28, 1
    s_lshl_b32 s31, s31, 13
    s_add_u32 s31, s31, 16384
    v_lshrrev_b32 v36, 1, v2
    v_xor_b32 v36, v36, v3
    v_lshlrev_b32_e64 v36, 4, v36
    v_lshl_add_u32 v36, v2, 7, v36
    v_add_u32 v42, s31, v36
    v_xor_b32_e64 v43, 64, v42
    s_waitcnt vmcnt(30)
    s_waitcnt vmcnt(22) lgkmcnt(0)
    s_barrier
    ds_read_b128 v[180:183], v42 offset:0
    ds_read_b64_tr_b16 v[164:165], v38 offset:0
    ds_read_b64_tr_b16 v[166:167], v38 offset:1024
    ds_read_b128 v[184:187], v42 offset:2048
    ds_read_b64_tr_b16 v[168:169], v39 offset:0
    ds_read_b64_tr_b16 v[170:171], v39 offset:1024
    ds_read_b128 v[188:191], v42 offset:4096
    ds_read_b64_tr_b16 v[172:173], v40 offset:0
    ds_read_b64_tr_b16 v[174:175], v40 offset:1024
    ds_read_b128 v[192:195], v42 offset:6144
    ds_read_b64_tr_b16 v[176:177], v41 offset:0
    ds_read_b64_tr_b16 v[178:179], v41 offset:1024
    s_lshr_b32 s31, s2, 4
    s_lshl_b32 s31, s31, 8
    s_and_b32 s32, s2, 15
    s_lshl_b32 s32, s32, 2
    s_add_u32 s31, s31, s32
    s_add_u32 s31, s31, 0xb00000
    v_lshlrev_b32 v44, 24, v0
    v_mov_b32_e64 v45, s54
    buffer_store_dword v45, v44, s[16:19], s31 offen sc1
    s_lshl_b32 s31, s30, 8
    v_add_u32 v44, s31, v0
    s_lshl_b32 s31, s30, 2
    s_add_u32 s31, s31, s28
    s_mul_i32 s31, s31, 14336
    v_lshl_add_u32 v44, v2, 7, s31
    v_lshl_add_u32 v44, v3, 28, v44
    s_waitcnt lgkmcnt(0)
    v_mfma_f32_16x16x32_bf16 v[100:103], v[164:167], v[180:183], 0
    ds_read_b128 v[212:215], v43 offset:0
    v_mfma_f32_16x16x32_bf16 v[116:119], v[164:167], v[184:187], 0
    ds_read_b64_tr_b16 v[196:197], v38 offset:8192
    v_mfma_f32_16x16x32_bf16 v[132:135], v[164:167], v[188:191], 0
    ds_read_b64_tr_b16 v[198:199], v38 offset:9216
    v_mfma_f32_16x16x32_bf16 v[148:151], v[164:167], v[192:195], 0
    ds_read_b128 v[216:219], v43 offset:2048
    v_mfma_f32_16x16x32_bf16 v[104:107], v[168:171], v[180:183], 0
    ds_read_b64_tr_b16 v[200:201], v39 offset:8192
    v_mfma_f32_16x16x32_bf16 v[120:123], v[168:171], v[184:187], 0
    ds_read_b64_tr_b16 v[202:203], v39 offset:9216
    v_mfma_f32_16x16x32_bf16 v[136:139], v[168:171], v[188:191], 0
    ds_read_b128 v[220:223], v43 offset:4096
    v_mfma_f32_16x16x32_bf16 v[152:155], v[168:171], v[192:195], 0
    ds_read_b64_tr_b16 v[204:205], v40 offset:8192
    v_mfma_f32_16x16x32_bf16 v[108:111], v[172:175], v[180:183], 0
    ds_read_b64_tr_b16 v[206:207], v40 offset:9216
    v_mfma_f32_16x16x32_bf16 v[124:127], v[172:175], v[184:187], 0
    ds_read_b128 v[224:227], v43 offset:6144
    v_mfma_f32_16x16x32_bf16 v[140:143], v[172:175], v[188:191], 0
    ds_read_b64_tr_b16 v[208:209], v41 offset:8192
    v_mfma_f32_16x16x32_bf16 v[156:159], v[172:175], v[192:195], 0
    ds_read_b64_tr_b16 v[210:211], v41 offset:9216
    v_mfma_f32_16x16x32_bf16 v[112:115], v[176:179], v[180:183], 0
    v_mfma_f32_16x16x32_bf16 v[128:131], v[176:179], v[184:187], 0
    v_mfma_f32_16x16x32_bf16 v[144:147], v[176:179], v[188:191], 0
    v_mfma_f32_16x16x32_bf16 v[160:163], v[176:179], v[192:195], 0
    s_waitcnt lgkmcnt(0)
    s_waitcnt vmcnt(17)
    s_barrier
    v_mfma_f32_16x16x32_bf16 v[100:103], v[196:199], v[212:215], v[100:103]
    ds_read_b128 v[180:183], v42 offset:32768
    s_lshr_b32 s33, s28, 1
    v_mfma_f32_16x16x32_bf16 v[116:119], v[196:199], v[216:219], v[116:119]
    ds_read_b64_tr_b16 v[164:165], v38 offset:32768
    s_and_b32 s34, s28, 1
    v_mfma_f32_16x16x32_bf16 v[132:135], v[196:199], v[220:223], v[132:135]
    ds_read_b64_tr_b16 v[166:167], v38 offset:33792
    s_mul_i32 s31, s33, 9216
    v_mfma_f32_16x16x32_bf16 v[148:151], v[196:199], v[224:227], v[148:151]
    s_add_u32 m0, s74, 16384
    s_nop 0
    buffer_load_dwordx4 v32, s[4:7], s73 offen offset:0 lds
    ds_read_b128 v[184:187], v42 offset:34816
    s_lshl_b32 s32, s34, 11
    v_mfma_f32_16x16x32_bf16 v[104:107], v[200:203], v[212:215], v[104:107]
    ds_read_b64_tr_b16 v[168:169], v39 offset:32768
    s_add_u32 s31, s31, s32
    v_mfma_f32_16x16x32_bf16 v[120:123], v[200:203], v[216:219], v[120:123]
    ds_read_b64_tr_b16 v[170:171], v39 offset:33792
    s_add_u32 s31, s31, 141312
    v_mfma_f32_16x16x32_bf16 v[136:139], v[200:203], v[220:223], v[136:139]
    ds_read_b128 v[188:191], v42 offset:36864
    v_add_u32 v46, s31, v6
    v_mfma_f32_16x16x32_bf16 v[152:155], v[200:203], v[224:227], v[152:155]
    buffer_load_dwordx4 v33, s[4:7], s73 offen offset:1024 lds
    ds_read_b64_tr_b16 v[172:173], v40 offset:32768
    ds_read_b128 v[228:231], v46 offset:0
    v_mfma_f32_16x16x32_bf16 v[108:111], v[204:207], v[212:215], v[108:111]
    ds_read_b64_tr_b16 v[174:175], v40 offset:33792
    ds_read_b128 v[232:235], v46 offset:1024
    v_mfma_f32_16x16x32_bf16 v[124:127], v[204:207], v[216:219], v[124:127]
    ds_read_b128 v[192:195], v42 offset:38912
    ds_read_b128 v[236:239], v46 offset:4608
    v_mfma_f32_16x16x32_bf16 v[140:143], v[204:207], v[220:223], v[140:143]
    ds_read_b64_tr_b16 v[176:177], v41 offset:32768
    ds_read_b128 v[240:243], v46 offset:5632
    v_mfma_f32_16x16x32_bf16 v[156:159], v[204:207], v[224:227], v[156:159]
    buffer_load_dwordx4 v34, s[4:7], s73 offen offset:2048 lds
    ds_read_b64_tr_b16 v[178:179], v41 offset:33792
    s_mul_i32 s32, s33, 4608
    v_mfma_f32_16x16x32_bf16 v[112:115], v[208:211], v[212:215], v[112:115]
    s_lshl_b32 s31, s34, 8
    v_mfma_f32_16x16x32_bf16 v[128:131], v[208:211], v[216:219], v[128:131]
    s_add_u32 s31, s31, s32
    v_mfma_f32_16x16x32_bf16 v[144:147], v[208:211], v[220:223], v[144:147]
    s_add_u32 s31, s31, 132096
    v_mfma_f32_16x16x32_bf16 v[160:163], v[208:211], v[224:227], v[160:163]
    buffer_load_dwordx4 v35, s[4:7], s73 offen offset:3072 lds
    s_add_u32 s73, s73, 128
    v_mov_b32 v47, 0x100
    s_waitcnt lgkmcnt(0)
    v_mfma_f32_16x16x32_bf16 v[100:103], v[164:167], v[180:183], v[100:103]
    ds_read_b128 v[212:215], v43 offset:32768
    v_lshlrev_b32 v47, v3, v47
    v_mfma_f32_16x16x32_bf16 v[116:119], v[164:167], v[184:187], v[116:119]
    ds_read_b64_tr_b16 v[196:197], v38 offset:40960
    v_and_b32 v47, 0xe00, v47
    v_mfma_f32_16x16x32_bf16 v[132:135], v[164:167], v[188:191], v[132:135]
    ds_read_b64_tr_b16 v[198:199], v38 offset:41984
    v_lshl_add_u32 v47, v2, 4, v47
    v_mfma_f32_16x16x32_bf16 v[148:151], v[164:167], v[192:195], v[148:151]
    s_add_u32 m0, s74, 0
    s_nop 0
    buffer_load_dwordx4 v28, s[8:11], s72 offen offset:0 lds
    ds_read_b128 v[216:219], v43 offset:34816
    v_add_u32_e64 v50, s31, v47
    v_mfma_f32_16x16x32_bf16 v[104:107], v[168:171], v[180:183], v[104:107]
    ds_read_b64_tr_b16 v[200:201], v39 offset:40960
    v_mov_b32_e64 v47, 0
    v_mfma_f32_16x16x32_bf16 v[120:123], v[168:171], v[184:187], v[120:123]
    ds_read_b64_tr_b16 v[202:203], v39 offset:41984
    v_lshl_add_u32 v48, v1, 2, s31
    v_mfma_f32_16x16x32_bf16 v[136:139], v[168:171], v[188:191], v[136:139]
    ds_read_b128 v[220:223], v43 offset:36864
    ds_write_b32 v48, v47
    v_mfma_f32_16x16x32_bf16 v[152:155], v[168:171], v[192:195], v[152:155]
    buffer_load_dwordx4 v29, s[8:11], s72 offen offset:1024 lds
    ds_read_b64_tr_b16 v[204:205], v40 offset:40960
    v_and_b32 v49, 0x7f, v0
    v_mfma_f32_16x16x32_bf16 v[108:111], v[172:175], v[180:183], v[108:111]
    ds_read_b64_tr_b16 v[206:207], v40 offset:41984
    v_cmp_eq_u32_e64 vcc, 0, v49
    v_mfma_f32_16x16x32_bf16 v[124:127], v[172:175], v[184:187], v[124:127]
    ds_read_b128 v[224:227], v43 offset:38912
    v_cndmask_b32_e64 v49, 0, v25, vcc
    v_mfma_f32_16x16x32_bf16 v[140:143], v[172:175], v[188:191], v[140:143]
    ds_read_b64_tr_b16 v[208:209], v41 offset:40960
    v_and_b32_e64 v47, 1, v0
    v_mfma_f32_16x16x32_bf16 v[156:159], v[172:175], v[192:195], v[156:159]
    buffer_load_dwordx4 v30, s[8:11], s72 offen offset:2048 lds
    ds_read_b64_tr_b16 v[210:211], v41 offset:41984
    v_cmp_eq_u32_e64 vcc, 0, v47
    v_mfma_f32_16x16x32_bf16 v[112:115], v[176:179], v[180:183], v[112:115]
    v_mfma_f32_16x16x32_bf16 v[128:131], v[176:179], v[184:187], v[128:131]
    v_add_f32_e64 v228, v228, v236
    v_mfma_f32_16x16x32_bf16 v[144:147], v[176:179], v[188:191], v[144:147]
    v_add_f32_e64 v229, v229, v237
    v_mfma_f32_16x16x32_bf16 v[160:163], v[176:179], v[192:195], v[160:163]
    buffer_load_dwordx4 v31, s[8:11], s72 offen offset:3072 lds
    s_add_u32 s72, s72, 229376
    v_add_f32 v230, v230, v238
    s_waitcnt lgkmcnt(0)
    s_waitcnt vmcnt(17)
    s_barrier
    v_mfma_f32_16x16x32_bf16 v[100:103], v[196:199], v[212:215], v[100:103]
    v_xor_b32 v38, 0x10000, v38
    v_xor_b32 v39, 0x10000, v39
    v_xor_b32 v40, 0x10000, v40
    v_xor_b32 v41, 0x10000, v41
    v_xor_b32 v42, 0x10000, v42
    v_xor_b32 v43, 0x10000, v43
    v_add_f32_e64 v231, v231, v239
    v_mfma_f32_16x16x32_bf16 v[116:119], v[196:199], v[216:219], v[116:119]
    ds_read_b128 v[180:183], v42 offset:0
    v_add_f32_e64 v232, v232, v240
    v_mfma_f32_16x16x32_bf16 v[132:135], v[196:199], v[220:223], v[132:135]
    ds_read_b64_tr_b16 v[164:165], v38 offset:0
    v_add_f32_e64 v233, v233, v241
    v_mfma_f32_16x16x32_bf16 v[148:151], v[196:199], v[224:227], v[148:151]
    s_add_u32 m0, s74, 49152
    s_nop 0
    buffer_load_dwordx4 v32, s[4:7], s73 offen offset:0 lds
    ds_read_b64_tr_b16 v[166:167], v38 offset:1024
    v_add_f32 v234, v234, v242
    v_mfma_f32_16x16x32_bf16 v[104:107], v[200:203], v[212:215], v[104:107]
    ds_read_b128 v[184:187], v42 offset:2048
    v_add_f32_e64 v235, v235, v243
    v_mfma_f32_16x16x32_bf16 v[120:123], v[200:203], v[216:219], v[120:123]
    ds_read_b64_tr_b16 v[168:169], v39 offset:0
    v_add_f32_e64 v228, v228, v49
    v_mfma_f32_16x16x32_bf16 v[136:139], v[200:203], v[220:223], v[136:139]
    ds_read_b64_tr_b16 v[170:171], v39 offset:1024
    v_cvt_pk_bf16_f32 v52, v228, v229
    v_mfma_f32_16x16x32_bf16 v[152:155], v[200:203], v[224:227], v[152:155]
    buffer_load_dwordx4 v33, s[4:7], s73 offen offset:1024 lds
    ds_read_b128 v[188:191], v42 offset:4096
    v_cvt_pk_bf16_f32 v53, v230, v231
    v_mfma_f32_16x16x32_bf16 v[108:111], v[204:207], v[212:215], v[108:111]
    ds_read_b64_tr_b16 v[172:173], v40 offset:0
    v_cvt_pk_bf16_f32 v54, v232, v233
    v_mfma_f32_16x16x32_bf16 v[124:127], v[204:207], v[216:219], v[124:127]
    ds_read_b64_tr_b16 v[174:175], v40 offset:1024
    v_cvt_pk_bf16_f32 v55, v234, v235
    v_mfma_f32_16x16x32_bf16 v[140:143], v[204:207], v[220:223], v[140:143]
    ds_read_b128 v[192:195], v42 offset:6144
    v_cvt_pk_bf16_f32 v56, v228, v228
    v_mfma_f32_16x16x32_bf16 v[156:159], v[204:207], v[224:227], v[156:159]
    buffer_load_dwordx4 v34, s[4:7], s73 offen offset:2048 lds
    ds_read_b64_tr_b16 v[176:177], v41 offset:0
    v_cvt_pk_bf16_f32 v57, v229, v230
    v_mfma_f32_16x16x32_bf16 v[112:115], v[208:211], v[212:215], v[112:115]
    ds_read_b64_tr_b16 v[178:179], v41 offset:1024
    v_cvt_pk_bf16_f32 v58, v230, v230
    v_mfma_f32_16x16x32_bf16 v[128:131], v[208:211], v[216:219], v[128:131]
    v_cvt_pk_bf16_f32 v59, v231, v232
    v_mfma_f32_16x16x32_bf16 v[144:147], v[208:211], v[220:223], v[144:147]
    v_cvt_pk_bf16_f32 v60, v228, v228
    v_mfma_f32_16x16x32_bf16 v[160:163], v[208:211], v[224:227], v[160:163]
    buffer_load_dwordx4 v35, s[4:7], s73 offen offset:3072 lds
    s_add_u32 s73, s73, 128
    v_cvt_pk_bf16_f32 v61, v228, v229
    s_waitcnt lgkmcnt(0)
    v_mfma_f32_16x16x32_bf16 v[100:103], v[164:167], v[180:183], v[100:103]
    ds_read_b128 v[212:215], v43 offset:0
    s_nop 0
    v_cvt_pk_bf16_f32 v62, v229, v229
    v_mfma_f32_16x16x32_bf16 v[116:119], v[164:167], v[184:187], v[116:119]
    ds_read_b64_tr_b16 v[196:197], v38 offset:8192
    v_cvt_pk_bf16_f32 v63, v230, v230
    v_mfma_f32_16x16x32_bf16 v[132:135], v[164:167], v[188:191], v[132:135]
    ds_read_b64_tr_b16 v[198:199], v38 offset:9216
    v_cvt_pk_bf16_f32 v64, v232, v232
    v_mfma_f32_16x16x32_bf16 v[148:151], v[164:167], v[192:195], v[148:151]
    s_add_u32 m0, s74, 32768
    s_nop 0
    buffer_load_dwordx4 v28, s[8:11], s72 offen offset:0 lds
    ds_read_b128 v[216:219], v43 offset:2048
    s_nop 0
    v_cvt_pk_bf16_f32 v65, v232, v233
    v_mfma_f32_16x16x32_bf16 v[104:107], v[168:171], v[180:183], v[104:107]
    ds_read_b64_tr_b16 v[200:201], v39 offset:8192
    v_cvt_pk_bf16_f32 v66, v233, v233
    v_mfma_f32_16x16x32_bf16 v[120:123], v[168:171], v[184:187], v[120:123]
    ds_read_b64_tr_b16 v[202:203], v39 offset:9216
    v_cvt_pk_bf16_f32 v67, v234, v234
    v_mfma_f32_16x16x32_bf16 v[136:139], v[168:171], v[188:191], v[136:139]
    ds_read_b128 v[220:223], v43 offset:4096
    v_cndmask_b32_e64 v46, v229, v228, vcc
    v_mfma_f32_16x16x32_bf16 v[152:155], v[168:171], v[192:195], v[152:155]
    buffer_load_dwordx4 v29, s[8:11], s72 offen offset:1024 lds
    ds_read_b64_tr_b16 v[204:205], v40 offset:8192
    v_cvt_pk_bf16_f32 v68, v228, v228
    v_mfma_f32_16x16x32_bf16 v[108:111], v[172:175], v[180:183], v[108:111]
    ds_read_b64_tr_b16 v[206:207], v40 offset:9216
    v_cvt_pk_bf16_f32 v69, v228, v228
    v_mfma_f32_16x16x32_bf16 v[124:127], v[172:175], v[184:187], v[124:127]
    ds_read_b128 v[224:227], v43 offset:6144
    v_cvt_pk_bf16_f32 v70, v46, v229
    v_mfma_f32_16x16x32_bf16 v[140:143], v[172:175], v[188:191], v[140:143]
    ds_read_b64_tr_b16 v[208:209], v41 offset:8192
    v_cvt_pk_bf16_f32 v71, v229, v229
    v_mfma_f32_16x16x32_bf16 v[156:159], v[172:175], v[192:195], v[156:159]
    buffer_load_dwordx4 v30, s[8:11], s72 offen offset:2048 lds
    ds_read_b64_tr_b16 v[210:211], v41 offset:9216
    v_cndmask_b32_e64 v46, v231, v230, vcc
    v_mfma_f32_16x16x32_bf16 v[112:115], v[176:179], v[180:183], v[112:115]
    v_cvt_pk_bf16_f32 v72, v230, v230
    v_mfma_f32_16x16x32_bf16 v[128:131], v[176:179], v[184:187], v[128:131]
    v_cvt_pk_bf16_f32 v73, v230, v230
    v_mfma_f32_16x16x32_bf16 v[144:147], v[176:179], v[188:191], v[144:147]
    v_cvt_pk_bf16_f32 v74, v46, v231
    v_mfma_f32_16x16x32_bf16 v[160:163], v[176:179], v[192:195], v[160:163]
    buffer_load_dwordx4 v31, s[8:11], s72 offen offset:3072 lds
    s_add_u32 s72, s72, 229376
    v_cvt_pk_bf16_f32 v75, v231, v231
    s_waitcnt lgkmcnt(0)
    s_waitcnt vmcnt(17)
    s_barrier
    v_mfma_f32_16x16x32_bf16 v[100:103], v[196:199], v[212:215], v[100:103]
    ds_read_b128 v[180:183], v42 offset:32768
    v_cndmask_b32 v46, v233, v232, vcc
    v_mfma_f32_16x16x32_bf16 v[116:119], v[196:199], v[216:219], v[116:119]
    buffer_load_dword v255, v44, s[12:15], 0 offen offset:0
    ds_read_b64_tr_b16 v[164:165], v38 offset:32768
    v_cvt_pk_bf16_f32 v76, v232, v232
    v_mfma_f32_16x16x32_bf16 v[132:135], v[196:199], v[220:223], v[132:135]
    ds_read_b64_tr_b16 v[166:167], v38 offset:33792
    v_cvt_pk_bf16_f32 v77, v232, v232
    v_mfma_f32_16x16x32_bf16 v[148:151], v[196:199], v[224:227], v[148:151]
    s_add_u32 m0, s74, 81920
    s_nop 0
    buffer_load_dwordx4 v32, s[4:7], s73 offen offset:0 lds
    ds_read_b128 v[184:187], v42 offset:34816
    s_nop 0
    v_cvt_pk_bf16_f32 v78, v46, v233
    v_mfma_f32_16x16x32_bf16 v[104:107], v[200:203], v[212:215], v[104:107]
    ds_read_b64_tr_b16 v[168:169], v39 offset:32768
    v_cvt_pk_bf16_f32 v79, v233, v233
    v_mfma_f32_16x16x32_bf16 v[120:123], v[200:203], v[216:219], v[120:123]
    ds_read_b64_tr_b16 v[170:171], v39 offset:33792
    v_cndmask_b32_e64 v46, v235, v234, vcc
    v_mfma_f32_16x16x32_bf16 v[136:139], v[200:203], v[220:223], v[136:139]
    ds_read_b128 v[188:191], v42 offset:36864
    v_cvt_pk_bf16_f32 v80, v234, v234
    v_mfma_f32_16x16x32_bf16 v[152:155], v[200:203], v[224:227], v[152:155]
    buffer_load_dwordx4 v33, s[4:7], s73 offen offset:1024 lds
    ds_read_b64_tr_b16 v[172:173], v40 offset:32768
    v_cvt_pk_bf16_f32 v81, v234, v234
    v_mfma_f32_16x16x32_bf16 v[108:111], v[204:207], v[212:215], v[108:111]
    ds_read_b64_tr_b16 v[174:175], v40 offset:33792
    v_cvt_pk_bf16_f32 v82, v46, v235
    v_mfma_f32_16x16x32_bf16 v[124:127], v[204:207], v[216:219], v[124:127]
    buffer_load_dword v255, v44, s[12:15], 0 offen offset:2048
    ds_read_b128 v[192:195], v42 offset:38912
    v_cvt_pk_bf16_f32 v83, v235, v235
    v_mfma_f32_16x16x32_bf16 v[140:143], v[204:207], v[220:223], v[140:143]
    ds_read_b64_tr_b16 v[176:177], v41 offset:32768
    s_bfm_b64 exec, 16, 0
    ds_write_b128 v50, v[52:55] offset:512
    s_bfm_b64 exec, 16, 16
    ds_write_b128 v50, v[56:59] offset:512
    s_mov_b64 exec, -1
    v_mfma_f32_16x16x32_bf16 v[156:159], v[204:207], v[224:227], v[156:159]
    buffer_load_dwordx4 v34, s[4:7], s73 offen offset:2048 lds
    ds_read_b64_tr_b16 v[178:179], v41 offset:33792
    s_bfm_b64 exec, 16, 32
    ds_write_b128 v50, v[60:63] offset:512
    ds_write_b128 v50, v[64:67] offset:1024
    s_mov_b64 exec, -1
    v_mfma_f32_16x16x32_bf16 v[112:115], v[208:211], v[212:215], v[112:115]
    s_bfm_b64 exec, 16, 48
    ds_write_b128 v50, v[68:71] offset:512
    ds_write_b128 v50, v[72:75] offset:1024
    s_mov_b64 exec, -1
    v_mfma_f32_16x16x32_bf16 v[128:131], v[208:211], v[216:219], v[128:131]
    s_bfm_b64 exec, 16, 48
    ds_write_b128 v50, v[76:79] offset:1536
    ds_write_b128 v50, v[80:83] offset:2048
    s_mov_b64 exec, -1
    v_mfma_f32_16x16x32_bf16 v[144:147], v[208:211], v[220:223], v[144:147]
    v_mfma_f32_16x16x32_bf16 v[160:163], v[208:211], v[224:227], v[160:163]
    buffer_load_dwordx4 v35, s[4:7], s73 offen offset:3072 lds
    s_add_u32 s73, s73, 128
    v_lshrrev_b32_e64 v246, 3, v1
    s_waitcnt lgkmcnt(6)
    v_mfma_f32_16x16x32_bf16 v[100:103], v[164:167], v[180:183], v[100:103]
    ds_read_b128 v[212:215], v43 offset:32768
    v_lshlrev_b32_e64 v246, 10, v246
    v_mfma_f32_16x16x32_bf16 v[116:119], v[164:167], v[184:187], v[116:119]
    v_add_u32 v44, 4096, v44
    buffer_load_dword v255, v44, s[12:15], 0 offen offset:0
    ds_read_b64_tr_b16 v[196:197], v38 offset:40960
    v_and_b32_e64 v250, 1, v3
    v_mfma_f32_16x16x32_bf16 v[132:135], v[164:167], v[188:191], v[132:135]
    ds_read_b64_tr_b16 v[198:199], v38 offset:41984
    v_lshlrev_b32_e64 v250, 2, v250
    v_mfma_f32_16x16x32_bf16 v[148:151], v[164:167], v[192:195], v[148:151]
    s_add_u32 m0, s74, 65536
    s_nop 0
    buffer_load_dwordx4 v28, s[8:11], s72 offen offset:0 lds
    ds_read_b128 v[216:219], v43 offset:34816
    v_and_b32 v251, 7, v1
    v_mfma_f32_16x16x32_bf16 v[104:107], v[168:171], v[180:183], v[104:107]
    ds_read_b64_tr_b16 v[200:201], v39 offset:40960
    v_xor_b32_e64 v250, v250, v251
    v_mfma_f32_16x16x32_bf16 v[120:123], v[168:171], v[184:187], v[120:123]
    ds_read_b64_tr_b16 v[202:203], v39 offset:41984
    v_lshl_add_u32 v246, v250, 4, v246
    v_mfma_f32_16x16x32_bf16 v[136:139], v[168:171], v[188:191], v[136:139]
    ds_read_b128 v[220:223], v43 offset:36864
    s_lshl_b32 s3, s80, 7
    v_mfma_f32_16x16x32_bf16 v[152:155], v[168:171], v[192:195], v[152:155]
    buffer_load_dwordx4 v29, s[8:11], s72 offen offset:1024 lds
    ds_read_b64_tr_b16 v[204:205], v40 offset:40960
    v_add_u32 v246, s3, v246
    v_mfma_f32_16x16x32_bf16 v[108:111], v[172:175], v[180:183], v[108:111]
    ds_read_b64_tr_b16 v[206:207], v40 offset:41984
    v_add_u32 v247, 7168, v246
    v_mfma_f32_16x16x32_bf16 v[124:127], v[172:175], v[184:187], v[124:127]
    buffer_load_dword v255, v44, s[12:15], 0 offen offset:2048
    ds_read_b128 v[224:227], v43 offset:38912
    v_add_u32 v248, 14336, v246
    v_mfma_f32_16x16x32_bf16 v[140:143], v[172:175], v[188:191], v[140:143]
    ds_read_b64_tr_b16 v[208:209], v41 offset:40960
    v_add_u32 v249, 21504, v246
    v_mfma_f32_16x16x32_bf16 v[156:159], v[172:175], v[192:195], v[156:159]
    buffer_load_dwordx4 v30, s[8:11], s72 offen offset:2048 lds
    ds_read_b64_tr_b16 v[210:211], v41 offset:41984
    s_lshl_b32 s3, s28, 13
    v_mfma_f32_16x16x32_bf16 v[112:115], v[176:179], v[180:183], v[112:115]
    s_mul_i32 s75, s28, 458752
    v_mfma_f32_16x16x32_bf16 v[128:131], v[176:179], v[184:187], v[128:131]
    s_add_u32 s25, s75, 458752
    v_mfma_f32_16x16x32_bf16 v[144:147], v[176:179], v[188:191], v[144:147]
    s_lshl_b32 s26, s24, 15
    v_mfma_f32_16x16x32_bf16 v[160:163], v[176:179], v[192:195], v[160:163]
    buffer_load_dwordx4 v31, s[8:11], s72 offen offset:3072 lds
    s_add_u32 s72, s72, 229376
    s_add_u32 s75, s75, s26
    s_waitcnt lgkmcnt(0)
    s_waitcnt vmcnt(20)
    s_barrier
    v_mfma_f32_16x16x32_bf16 v[100:103], v[196:199], v[212:215], v[100:103]
    v_xor_b32 v38, 0x10000, v38
    v_xor_b32 v39, 0x10000, v39
    v_xor_b32 v40, 0x10000, v40
    v_xor_b32 v41, 0x10000, v41
    v_xor_b32 v42, 0x10000, v42
    v_xor_b32 v43, 0x10000, v43
    v_lshl_add_u32 v250, v3, 2, v4
    v_mfma_f32_16x16x32_bf16 v[116:119], v[196:199], v[216:219], v[116:119]
    v_lshrrev_b32 v46, 2, v1
    v_lshlrev_b32 v46, 8, v46
    v_lshl_add_u32 v46, v5, 4, v46
    s_lshl_b32 s76, s28, 26
    s_add_u32 s76, s76, 0xb00000
    v_add_u32 v46, s76, v46
    buffer_load_dwordx4 v[48:51], v46, s[16:19], 0 offen sc1
    v_add_u32 v44, 4096, v44
    buffer_load_dword v255, v44, s[12:15], 0 offen offset:0
    ds_read_b128 v[180:183], v42 offset:0
    v_lshlrev_b32_e64 v250, 7, v250
    v_mfma_f32_16x16x32_bf16 v[132:135], v[196:199], v[220:223], v[132:135]
    ds_read_b64_tr_b16 v[164:165], v38 offset:0
    v_lshl_add_u32 v250, v5, 4, v250
    v_mfma_f32_16x16x32_bf16 v[148:151], v[196:199], v[224:227], v[148:151]
    s_add_u32 m0, s74, 114688
    s_nop 0
    buffer_load_dwordx4 v32, s[4:7], s73 offen offset:0 lds
    ds_read_b64_tr_b16 v[166:167], v38 offset:1024
    v_add_u32 v250, s3, v250
    v_mfma_f32_16x16x32_bf16 v[104:107], v[200:203], v[212:215], v[104:107]
    ds_read_b128 v[184:187], v42 offset:2048
    v_and_b32_e64 v251, 2, v4
    v_mfma_f32_16x16x32_bf16 v[120:123], v[200:203], v[216:219], v[120:123]
    ds_read_b64_tr_b16 v[168:169], v39 offset:0
    v_lshl_add_u32 v250, v251, 5, v250
    v_mfma_f32_16x16x32_bf16 v[136:139], v[200:203], v[220:223], v[136:139]
    ds_read_b64_tr_b16 v[170:171], v39 offset:1024
    v_xor_b32_e64 v251, 64, v250
    v_mfma_f32_16x16x32_bf16 v[152:155], v[200:203], v[224:227], v[152:155]
    buffer_load_dwordx4 v33, s[4:7], s73 offen offset:1024 lds
    ds_read_b128 v[188:191], v42 offset:4096
    v_add_u32 v252, 0x10000, v250
    v_mfma_f32_16x16x32_bf16 v[108:111], v[204:207], v[212:215], v[108:111]
    ds_read_b64_tr_b16 v[172:173], v40 offset:0
    v_add_u32 v253, 0x10000, v251
    v_mfma_f32_16x16x32_bf16 v[124:127], v[204:207], v[216:219], v[124:127]
    buffer_load_dword v255, v44, s[12:15], 0 offen offset:2048
    ds_read_b64_tr_b16 v[174:175], v40 offset:1024
    v_mfma_f32_16x16x32_bf16 v[140:143], v[204:207], v[220:223], v[140:143]
    ds_read_b128 v[192:195], v42 offset:6144
    v_mfma_f32_16x16x32_bf16 v[156:159], v[204:207], v[224:227], v[156:159]
    buffer_load_dwordx4 v34, s[4:7], s73 offen offset:2048 lds
    ds_read_b64_tr_b16 v[176:177], v41 offset:0
    v_mfma_f32_16x16x32_bf16 v[112:115], v[208:211], v[212:215], v[112:115]
    ds_read_b64_tr_b16 v[178:179], v41 offset:1024
    v_mfma_f32_16x16x32_bf16 v[128:131], v[208:211], v[216:219], v[128:131]
    v_mfma_f32_16x16x32_bf16 v[144:147], v[208:211], v[220:223], v[144:147]
    v_mfma_f32_16x16x32_bf16 v[160:163], v[208:211], v[224:227], v[160:163]
    buffer_load_dwordx4 v35, s[4:7], s73 offen offset:3072 lds
    s_add_u32 s73, s73, 128
    s_waitcnt lgkmcnt(0)
    v_mfma_f32_16x16x32_bf16 v[100:103], v[164:167], v[180:183], v[100:103]
    ds_read_b128 v[212:215], v43 offset:0
    v_mfma_f32_16x16x32_bf16 v[116:119], v[164:167], v[184:187], v[116:119]
    s_nop 0
    v_add_u32 v44, 4096, v44
    buffer_load_dword v255, v44, s[12:15], 0 offen offset:0
    ds_read_b64_tr_b16 v[196:197], v38 offset:8192
    v_mfma_f32_16x16x32_bf16 v[132:135], v[164:167], v[188:191], v[132:135]
    ds_read_b64_tr_b16 v[198:199], v38 offset:9216
    v_mfma_f32_16x16x32_bf16 v[148:151], v[164:167], v[192:195], v[148:151]
    s_add_u32 m0, s74, 98304
    s_nop 0
    buffer_load_dwordx4 v28, s[8:11], s72 offen offset:0 lds
    ds_read_b128 v[216:219], v43 offset:2048
    v_mfma_f32_16x16x32_bf16 v[104:107], v[168:171], v[180:183], v[104:107]
    ds_read_b64_tr_b16 v[200:201], v39 offset:8192
    v_mfma_f32_16x16x32_bf16 v[120:123], v[168:171], v[184:187], v[120:123]
    ds_read_b64_tr_b16 v[202:203], v39 offset:9216
    v_mfma_f32_16x16x32_bf16 v[136:139], v[168:171], v[188:191], v[136:139]
    ds_read_b128 v[220:223], v43 offset:4096
    v_mfma_f32_16x16x32_bf16 v[152:155], v[168:171], v[192:195], v[152:155]
    buffer_load_dwordx4 v29, s[8:11], s72 offen offset:1024 lds
    ds_read_b64_tr_b16 v[204:205], v40 offset:8192
    v_mfma_f32_16x16x32_bf16 v[108:111], v[172:175], v[180:183], v[108:111]
    ds_read_b64_tr_b16 v[206:207], v40 offset:9216
    v_mfma_f32_16x16x32_bf16 v[124:127], v[172:175], v[184:187], v[124:127]
    ds_read_b128 v[224:227], v43 offset:6144
    v_mfma_f32_16x16x32_bf16 v[140:143], v[172:175], v[188:191], v[140:143]
    ds_read_b64_tr_b16 v[208:209], v41 offset:8192
    v_mfma_f32_16x16x32_bf16 v[156:159], v[172:175], v[192:195], v[156:159]
    buffer_load_dwordx4 v30, s[8:11], s72 offen offset:2048 lds
    ds_read_b64_tr_b16 v[210:211], v41 offset:9216
    v_mfma_f32_16x16x32_bf16 v[112:115], v[176:179], v[180:183], v[112:115]
    v_mfma_f32_16x16x32_bf16 v[128:131], v[176:179], v[184:187], v[128:131]
    s_lshl_b32 s31, s70, 11
    s_lshl_b32 s32, s28, 10
    s_add_u32 s31, s31, s32
    s_add_u32 s31, s31, 0xb10000
    s_add_u32 s32, s32, 159744
    s_lshl_b32 s33, s71, 10
    s_add_u32 s33, s33, 0xb20000
    s_cmp_lt_u32 s28, 2
    s_cselect_b32 s33, s31, s33
    s_cselect_b32 s34, s32, 161792
    v_lshrrev_b32 v44, 1, v0
    v_lshlrev_b32 v44, 13, v44
    v_and_b32 v45, 1, v0
    v_lshl_add_u32 v44, v45, 4, v44
    v_add_u32 v45, -8184, v44
    v_cmp_gt_u32 vcc, 2, v2
    s_lshl_b32 s35, s78, 5
    s_add_u32 s35, s35, 0x700000
    v_cndmask_b32_e64 v45, 2.0, v45, vcc
    v_mfma_f32_16x16x32_bf16 v[144:147], v[176:179], v[188:191], v[144:147]
    v_mfma_f32_16x16x32_bf16 v[160:163], v[176:179], v[192:195], v[160:163]
    buffer_load_dwordx4 v31, s[8:11], s72 offen offset:3072 lds
    s_add_u32 s72, s72, 229376
    s_waitcnt lgkmcnt(0)
    s_waitcnt vmcnt(24)
    s_barrier
    v_mfma_f32_16x16x32_bf16 v[100:103], v[196:199], v[212:215], v[100:103]
    s_add_u32 m0, s3, 0
    s_nop 0
    buffer_load_dwordx4 v246, s[12:15], s75 offen offset:0 lds
    ds_read_b128 v[180:183], v42 offset:32768
    v_mfma_f32_16x16x32_bf16 v[116:119], v[196:199], v[216:219], v[116:119]
    ds_read_b64_tr_b16 v[164:165], v38 offset:32768
    v_mfma_f32_16x16x32_bf16 v[132:135], v[196:199], v[220:223], v[132:135]
    ds_read_b64_tr_b16 v[166:167], v38 offset:33792
    v_mfma_f32_16x16x32_bf16 v[148:151], v[196:199], v[224:227], v[148:151]
    ds_read_b128 v[184:187], v42 offset:34816
    v_mfma_f32_16x16x32_bf16 v[104:107], v[200:203], v[212:215], v[104:107]
    ds_read_b64_tr_b16 v[168:169], v39 offset:32768
    v_mfma_f32_16x16x32_bf16 v[120:123], v[200:203], v[216:219], v[120:123]
    ds_read_b64_tr_b16 v[170:171], v39 offset:33792
    v_mfma_f32_16x16x32_bf16 v[136:139], v[200:203], v[220:223], v[136:139]
    buffer_load_dwordx4 v247, s[12:15], s75 offen offset:1024 lds
    ds_read_b128 v[188:191], v42 offset:36864
    v_mfma_f32_16x16x32_bf16 v[152:155], v[200:203], v[224:227], v[152:155]
    ds_read_b64_tr_b16 v[172:173], v40 offset:32768
    v_mfma_f32_16x16x32_bf16 v[108:111], v[204:207], v[212:215], v[108:111]
    ds_read_b64_tr_b16 v[174:175], v40 offset:33792
    v_mfma_f32_16x16x32_bf16 v[124:127], v[204:207], v[216:219], v[124:127]
    ds_read_b128 v[192:195], v42 offset:38912
    v_mfma_f32_16x16x32_bf16 v[140:143], v[204:207], v[220:223], v[140:143]
    ds_read_b64_tr_b16 v[176:177], v41 offset:32768
    v_mfma_f32_16x16x32_bf16 v[156:159], v[204:207], v[224:227], v[156:159]
    ds_read_b64_tr_b16 v[178:179], v41 offset:33792
    v_mfma_f32_16x16x32_bf16 v[112:115], v[208:211], v[212:215], v[112:115]
    buffer_load_dwordx4 v248, s[12:15], s75 offen offset:2048 lds
    v_mfma_f32_16x16x32_bf16 v[128:131], v[208:211], v[216:219], v[128:131]
    v_mfma_f32_16x16x32_bf16 v[144:147], v[208:211], v[220:223], v[144:147]
    v_mfma_f32_16x16x32_bf16 v[160:163], v[208:211], v[224:227], v[160:163]
    s_waitcnt lgkmcnt(0)
    v_mfma_f32_16x16x32_bf16 v[100:103], v[164:167], v[180:183], v[100:103]
    ds_read_b128 v[212:215], v43 offset:32768
    v_mfma_f32_16x16x32_bf16 v[116:119], v[164:167], v[184:187], v[116:119]
    ds_read_b64_tr_b16 v[196:197], v38 offset:40960
    v_mfma_f32_16x16x32_bf16 v[132:135], v[164:167], v[188:191], v[132:135]
    buffer_load_dwordx4 v249, s[12:15], s75 offen offset:3072 lds
    s_add_u32 s75, s75, 32768
    s_cmp_eq_u32 s75, s25
    s_cselect_b32 s27, 458752, 0
    s_sub_u32 s75, s75, s27
    ds_read_b64_tr_b16 v[198:199], v38 offset:41984
    v_mfma_f32_16x16x32_bf16 v[148:151], v[164:167], v[192:195], v[148:151]
    ds_read_b128 v[216:219], v43 offset:34816
    v_mfma_f32_16x16x32_bf16 v[104:107], v[168:171], v[180:183], v[104:107]
    ds_read_b64_tr_b16 v[200:201], v39 offset:40960
    v_mfma_f32_16x16x32_bf16 v[120:123], v[168:171], v[184:187], v[120:123]
    ds_read_b64_tr_b16 v[202:203], v39 offset:41984
    v_mfma_f32_16x16x32_bf16 v[136:139], v[168:171], v[188:191], v[136:139]
    ds_read_b128 v[220:223], v43 offset:36864
    v_mfma_f32_16x16x32_bf16 v[152:155], v[168:171], v[192:195], v[152:155]
    ds_read_b64_tr_b16 v[204:205], v40 offset:40960
    v_mfma_f32_16x16x32_bf16 v[108:111], v[172:175], v[180:183], v[108:111]
    s_add_u32 m0, s3, 4096
    s_nop 0
    buffer_load_dwordx4 v246, s[12:15], s75 offen offset:0 lds
    ds_read_b64_tr_b16 v[206:207], v40 offset:41984
    v_mfma_f32_16x16x32_bf16 v[124:127], v[172:175], v[184:187], v[124:127]
    ds_read_b128 v[224:227], v43 offset:38912
    v_mfma_f32_16x16x32_bf16 v[140:143], v[172:175], v[188:191], v[140:143]
    ds_read_b64_tr_b16 v[208:209], v41 offset:40960
    v_mfma_f32_16x16x32_bf16 v[156:159], v[172:175], v[192:195], v[156:159]
    ds_read_b64_tr_b16 v[210:211], v41 offset:41984
    v_mfma_f32_16x16x32_bf16 v[112:115], v[176:179], v[180:183], v[112:115]
    v_mfma_f32_16x16x32_bf16 v[128:131], v[176:179], v[184:187], v[128:131]
    s_and_b32 s31, s28, 1
    s_lshl_b32 s31, s31, 10
    s_add_u32 s31, s31, 159744
    s_nop 0
    v_lshl_add_u32 v36, v2, 4, s31
    s_and_b32 s31, s28, 2
    s_lshl_b32 s31, s31, 8
    s_add_u32 s31, s31, 161792
    v_lshl_add_u32 v37, v2, 3, s31
    v_lshl_add_u32 v37, v3, 18, v37
    v_mfma_f32_16x16x32_bf16 v[144:147], v[176:179], v[188:191], v[144:147]
    buffer_load_dwordx4 v247, s[12:15], s75 offen offset:1024 lds
    v_mfma_f32_16x16x32_bf16 v[160:163], v[176:179], v[192:195], v[160:163]
    s_waitcnt lgkmcnt(0)
    s_waitcnt vmcnt(18)
    s_waitcnt vmcnt(17)
    s_cmp_lg_u32 s28, 0
    s_cbranch_scc1 XP_4
    v_xor_b32 v49, v49, v48
    v_xor_b32 v50, v50, v48
    v_xor_b32 v51, v51, v48
    v_xor_b32_e64 v48, s54, v48
    v_or3_b32 v49, v49, v50, v51
    v_or_b32 v48, v48, v49
    v_cmp_ne_u32 vcc, 0, v48
    s_mov_b32 s81, 0x10000
    s_cbranch_vccz OK_6
POLL_5:
    s_sub_u32 s81, s81, 1
    s_cbranch_scc1 OK_6
    s_sleep 8
    buffer_load_dwordx4 v[48:51], v46, s[16:19], 0 offen sc1
    s_waitcnt vmcnt(0)
    v_xor_b32 v49, v49, v48
    v_xor_b32 v50, v50, v48
    v_xor_b32 v51, v51, v48
    v_xor_b32_e64 v48, s54, v48
    v_or3_b32 v49, v49, v50, v51
    v_or_b32 v48, v48, v49
    v_cmp_ne_u32_e64 vcc, 0, v48
    s_nop 1
    s_cbranch_vccnz POLL_5
OK_6:
XP_4:
    s_barrier
    v_mfma_f32_16x16x32_bf16 v[100:103], v[196:199], v[212:215], v[100:103]
    v_xor_b32 v38, 0x10000, v38
    v_xor_b32 v39, 0x10000, v39
    v_xor_b32 v40, 0x10000, v40
    v_xor_b32 v41, 0x10000, v41
    v_xor_b32 v42, 0x10000, v42
    v_xor_b32 v43, 0x10000, v43
    v_mfma_f32_16x16x32_bf16 v[116:119], v[196:199], v[216:219], v[116:119]
    ds_read_b128 v[180:183], v42 offset:0
    v_mfma_f32_16x16x32_bf16 v[132:135], v[196:199], v[220:223], v[132:135]
    ds_read_b64_tr_b16 v[164:165], v38 offset:0
    v_mfma_f32_16x16x32_bf16 v[148:151], v[196:199], v[224:227], v[148:151]
    ds_read_b64_tr_b16 v[166:167], v38 offset:1024
    v_mfma_f32_16x16x32_bf16 v[104:107], v[200:203], v[212:215], v[104:107]
    buffer_load_dwordx4 v248, s[12:15], s75 offen offset:2048 lds
    ds_read_b128 v[184:187], v42 offset:2048
    v_mfma_f32_16x16x32_bf16 v[120:123], v[200:203], v[216:219], v[120:123]
    ds_read_b64_tr_b16 v[168:169], v39 offset:0
    v_mfma_f32_16x16x32_bf16 v[136:139], v[200:203], v[220:223], v[136:139]
    ds_read_b64_tr_b16 v[170:171], v39 offset:1024
    v_mfma_f32_16x16x32_bf16 v[152:155], v[200:203], v[224:227], v[152:155]
    ds_read_b128 v[188:191], v42 offset:4096
    v_mfma_f32_16x16x32_bf16 v[108:111], v[204:207], v[212:215], v[108:111]
    ds_read_b64_tr_b16 v[172:173], v40 offset:0
    v_mfma_f32_16x16x32_bf16 v[124:127], v[204:207], v[216:219], v[124:127]
    ds_read_b64_tr_b16 v[174:175], v40 offset:1024
    v_mfma_f32_16x16x32_bf16 v[140:143], v[204:207], v[220:223], v[140:143]
    buffer_load_dwordx4 v249, s[12:15], s75 offen offset:3072 lds
    s_add_u32 s75, s75, 32768
    s_cmp_eq_u32 s75, s25
    s_cselect_b32 s27, 458752, 0
    s_sub_u32 s75, s75, s27
    ds_read_b128 v[192:195], v42 offset:6144
    v_mfma_f32_16x16x32_bf16 v[156:159], v[204:207], v[224:227], v[156:159]
    ds_read_b64_tr_b16 v[176:177], v41 offset:0
    v_mfma_f32_16x16x32_bf16 v[112:115], v[208:211], v[212:215], v[112:115]
    ds_read_b64_tr_b16 v[178:179], v41 offset:1024
    v_mfma_f32_16x16x32_bf16 v[128:131], v[208:211], v[216:219], v[128:131]
    v_mfma_f32_16x16x32_bf16 v[144:147], v[208:211], v[220:223], v[144:147]
    v_mfma_f32_16x16x32_bf16 v[160:163], v[208:211], v[224:227], v[160:163]
    s_waitcnt lgkmcnt(0)
    v_mfma_f32_16x16x32_bf16 v[100:103], v[164:167], v[180:183], v[100:103]
    s_mov_b32 m0, s34
    s_nop 0
    buffer_load_dwordx4 v6, s[16:19], s33 offen sc1 lds
    ds_read_b128 v[212:215], v43 offset:0
    v_mfma_f32_16x16x32_bf16 v[116:119], v[164:167], v[184:187], v[116:119]
    ds_read_b64_tr_b16 v[196:197], v38 offset:8192
    s_lshr_b32 s74, s28, 1
    v_mfma_f32_16x16x32_bf16 v[132:135], v[164:167], v[188:191], v[132:135]
    ds_read_b64_tr_b16 v[198:199], v38 offset:9216
    s_mul_i32 s31, s74, 16704
    v_mfma_f32_16x16x32_bf16 v[148:151], v[164:167], v[192:195], v[148:151]
    ds_read_b128 v[216:219], v43 offset:2048
    s_and_b32 s32, s28, 1
    v_mfma_f32_16x16x32_bf16 v[104:107], v[168:171], v[180:183], v[104:107]
    ds_read_b64_tr_b16 v[200:201], v39 offset:8192
    s_lshl_b32 s32, s32, 8
    v_mfma_f32_16x16x32_bf16 v[120:123], v[168:171], v[184:187], v[120:123]
    ds_read_b64_tr_b16 v[202:203], v39 offset:9216
    s_add_u32 s31, s31, s32
    v_mfma_f32_16x16x32_bf16 v[136:139], v[168:171], v[188:191], v[136:139]
    buffer_load_dwordx4 v[232:235], v44, s[16:19], s35 offen sc1
    ds_read_b128 v[220:223], v43 offset:4096
    s_add_u32 s31, s31, 98360
    v_mfma_f32_16x16x32_bf16 v[152:155], v[168:171], v[192:195], v[152:155]
    ds_read_b64_tr_b16 v[204:205], v40 offset:8192
    s_nop 0
    v_mul_u32_u24 v8, 4160, v4
    v_mfma_f32_16x16x32_bf16 v[108:111], v[172:175], v[180:183], v[108:111]
    ds_read_b64_tr_b16 v[206:207], v40 offset:9216
    v_lshl_add_u32 v8, v5, 3, v8
    v_mfma_f32_16x16x32_bf16 v[124:127], v[172:175], v[184:187], v[124:127]
    ds_read_b128 v[224:227], v43 offset:6144
    v_lshlrev_b32_e64 v10, 4, v3
    v_mfma_f32_16x16x32_bf16 v[140:143], v[172:175], v[188:191], v[140:143]
    ds_read_b64_tr_b16 v[208:209], v41 offset:8192
    v_sub_u32_e64 v8, v8, v10
    v_mfma_f32_16x16x32_bf16 v[156:159], v[172:175], v[192:195], v[156:159]
    ds_read_b64_tr_b16 v[210:211], v41 offset:9216
    v_add_u32_e64 v8, s31, v8
    v_mfma_f32_16x16x32_bf16 v[112:115], v[176:179], v[180:183], v[112:115]
    buffer_load_dwordx2 v[230:231], v45, s[16:19], s35 offen sc1
    v_add_u32 v44, 0x100000, v44
    v_add_u32 v45, 0x100000, v45
    s_mul_i32 s31, s74, 4608
    v_mfma_f32_16x16x32_bf16 v[128:131], v[176:179], v[184:187], v[128:131]
    s_sub_u32 s31, s31, s32
    v_mfma_f32_16x16x32_bf16 v[144:147], v[176:179], v[188:191], v[144:147]
    s_add_u32 s31, s31, 132384
    v_mfma_f32_16x16x32_bf16 v[160:163], v[176:179], v[192:195], v[160:163]
    s_nop 0
    v_lshl_add_u32 v9, v2, 5, v10
    s_waitcnt lgkmcnt(0)
    s_waitcnt vmcnt(11)
    s_barrier
    v_mfma_f32_16x16x32_bf16 v[100:103], v[196:199], v[212:215], v[100:103]
    ds_read_b128 v[180:183], v42 offset:32768
    v_add_u32 v9, s31, v9
    v_mfma_f32_16x16x32_bf16 v[116:119], v[196:199], v[216:219], v[116:119]
    ds_read_b64_tr_b16 v[164:165], v38 offset:32768
    s_lshl_b32 s31, s80, 7
    v_mfma_f32_16x16x32_bf16 v[132:135], v[196:199], v[220:223], v[132:135]
    buffer_load_dwordx4 v[240:243], v44, s[16:19], s35 offen sc1
    ds_read_b64_tr_b16 v[166:167], v38 offset:33792
    s_nop 0
    v_lshl_add_u32 v12, v3, 4, s31
    v_mfma_f32_16x16x32_bf16 v[148:151], v[196:199], v[224:227], v[148:151]
    ds_read_b128 v[184:187], v42 offset:34816
    v_lshl_add_u32 v11, v2, 10, v12
    v_mfma_f32_16x16x32_bf16 v[104:107], v[200:203], v[212:215], v[104:107]
    ds_read_b64_tr_b16 v[168:169], v39 offset:32768
    s_lshl_b32 s31, s79, 16
    v_mfma_f32_16x16x32_bf16 v[120:123], v[200:203], v[216:219], v[120:123]
    ds_read_b64_tr_b16 v[170:171], v39 offset:33792
    s_lshl_b32 s32, s28, 14
    v_mfma_f32_16x16x32_bf16 v[136:139], v[200:203], v[220:223], v[136:139]
    ds_read_b128 v[188:191], v42 offset:36864
    s_add_u32 s31, s31, s32
    v_mfma_f32_16x16x32_bf16 v[152:155], v[200:203], v[224:227], v[152:155]
    ds_read_b64_tr_b16 v[172:173], v40 offset:32768
    v_add_u32 v11, s31, v11
    v_mfma_f32_16x16x32_bf16 v[108:111], v[204:207], v[212:215], v[108:111]
    buffer_load_dwordx2 v[238:239], v45, s[16:19], s35 offen sc1
    ds_read_b64_tr_b16 v[174:175], v40 offset:33792
    s_mul_i32 s31, s79, 229376
    v_mfma_f32_16x16x32_bf16 v[124:127], v[204:207], v[216:219], v[124:127]
    ds_read_b128 v[192:195], v42 offset:38912
    s_mul_i32 s32, s28, 14336
    v_mfma_f32_16x16x32_bf16 v[140:143], v[204:207], v[220:223], v[140:143]
    ds_read_b64_tr_b16 v[176:177], v41 offset:32768
    s_add_u32 s31, s31, s32
    v_mfma_f32_16x16x32_bf16 v[156:159], v[204:207], v[224:227], v[156:159]
    ds_read_b64_tr_b16 v[178:179], v41 offset:33792
    s_xor_b32 s72, s28, 0
    v_mfma_f32_16x16x32_bf16 v[112:115], v[208:211], v[212:215], v[112:115]
    s_mul_i32 s72, s72, 57344
    v_mfma_f32_16x16x32_bf16 v[128:131], v[208:211], v[216:219], v[128:131]
    s_add_u32 s72, s72, s31
    v_mfma_f32_16x16x32_bf16 v[144:147], v[208:211], v[220:223], v[144:147]
    s_add_u32 m0, s3, 32768
    s_nop 0
    buffer_load_dwordx4 v246, s[12:15], s75 offen offset:0 lds
    s_xor_b32 s73, s28, 1
    v_mfma_f32_16x16x32_bf16 v[160:163], v[208:211], v[224:227], v[160:163]
    s_mul_i32 s73, s73, 57344
    s_waitcnt lgkmcnt(0)
    v_mfma_f32_16x16x32_bf16 v[100:103], v[164:167], v[180:183], v[100:103]
    ds_read_b128 v[212:215], v43 offset:32768
    s_add_u32 s73, s73, s31
    v_mfma_f32_16x16x32_bf16 v[116:119], v[164:167], v[184:187], v[116:119]
    ds_read_b64_tr_b16 v[196:197], v38 offset:40960
    s_xor_b32 s76, s28, 2
    v_mfma_f32_16x16x32_bf16 v[132:135], v[164:167], v[188:191], v[132:135]
    ds_read_b64_tr_b16 v[198:199], v38 offset:41984
    s_mul_i32 s76, s76, 57344
    v_mfma_f32_16x16x32_bf16 v[148:151], v[164:167], v[192:195], v[148:151]
    ds_read_b128 v[216:219], v43 offset:34816
    s_add_u32 s76, s76, s31
    v_mfma_f32_16x16x32_bf16 v[104:107], v[168:171], v[180:183], v[104:107]
    buffer_load_dwordx4 v247, s[12:15], s75 offen offset:1024 lds
    ds_read_b64_tr_b16 v[200:201], v39 offset:40960
    s_xor_b32 s77, s28, 3
    v_mfma_f32_16x16x32_bf16 v[120:123], v[168:171], v[184:187], v[120:123]
    ds_read_b64_tr_b16 v[202:203], v39 offset:41984
    s_mul_i32 s77, s77, 57344
    v_mfma_f32_16x16x32_bf16 v[136:139], v[168:171], v[188:191], v[136:139]
    ds_read_b128 v[220:223], v43 offset:36864
    s_add_u32 s77, s77, s31
    v_mfma_f32_16x16x32_bf16 v[152:155], v[168:171], v[192:195], v[152:155]
    ds_read_b64_tr_b16 v[204:205], v40 offset:40960
    s_lshl_b32 s26, s24, 10
    v_mfma_f32_16x16x32_bf16 v[108:111], v[172:175], v[180:183], v[108:111]
    ds_read_b64_tr_b16 v[206:207], v40 offset:41984
    v_add_u32_e64 v13, s26, v6
    v_mfma_f32_16x16x32_bf16 v[124:127], v[172:175], v[184:187], v[124:127]
    ds_read_b128 v[224:227], v43 offset:38912
    v_mfma_f32_16x16x32_bf16 v[140:143], v[172:175], v[188:191], v[140:143]
    buffer_load_dwordx4 v248, s[12:15], s75 offen offset:2048 lds
    ds_read_b64_tr_b16 v[208:209], v41 offset:40960
    v_mfma_f32_16x16x32_bf16 v[156:159], v[172:175], v[192:195], v[156:159]
    ds_read_b64_tr_b16 v[210:211], v41 offset:41984
    v_mfma_f32_16x16x32_bf16 v[112:115], v[176:179], v[180:183], v[112:115]
    v_mfma_f32_16x16x32_bf16 v[128:131], v[176:179], v[184:187], v[128:131]
    v_mfma_f32_16x16x32_bf16 v[144:147], v[176:179], v[188:191], v[144:147]
    v_mfma_f32_16x16x32_bf16 v[160:163], v[176:179], v[192:195], v[160:163]
    s_waitcnt lgkmcnt(0)
    s_waitcnt vmcnt(7)
    s_barrier
    v_mfma_f32_16x16x32_bf16 v[100:103], v[196:199], v[212:215], v[100:103]
    buffer_load_dwordx4 v249, s[12:15], s75 offen offset:3072 lds
    s_add_u32 s75, s75, 32768
    s_cmp_eq_u32 s75, s25
    s_cselect_b32 s27, 458752, 0
    s_sub_u32 s75, s75, s27
    ds_read_b128 v[52:55], v36 offset:0
    ds_read_b64 v[68:69], v37 offset:0
    v_mfma_f32_16x16x32_bf16 v[116:119], v[196:199], v[216:219], v[116:119]
    ds_read_b128 v[56:59], v36 offset:256
    ds_read_b64 v[70:71], v37 offset:128
    v_mfma_f32_16x16x32_bf16 v[132:135], v[196:199], v[220:223], v[132:135]
    ds_read_b128 v[60:63], v36 offset:512
    ds_read_b64 v[72:73], v37 offset:256
    v_mfma_f32_16x16x32_bf16 v[148:151], v[196:199], v[224:227], v[148:151]
    ds_read_b128 v[64:67], v36 offset:768
    ds_read_b64 v[74:75], v37 offset:384
    v_mfma_f32_16x16x32_bf16 v[104:107], v[200:203], v[212:215], v[104:107]
    v_mfma_f32_16x16x32_bf16 v[120:123], v[200:203], v[216:219], v[120:123]
    v_mfma_f32_16x16x32_bf16 v[136:139], v[200:203], v[220:223], v[136:139]
    s_add_u32 m0, s3, 36864
    s_nop 0
    buffer_load_dwordx4 v246, s[12:15], s75 offen offset:0 lds
    ds_read_b64_tr_b16 a[0:1], v250 offset:0
    ds_read_b64_tr_b16 a[2:3], v250 offset:2048
    v_mfma_f32_16x16x32_bf16 v[152:155], v[200:203], v[224:227], v[152:155]
    ds_read_b64_tr_b16 a[4:5], v250 offset:8
    ds_read_b64_tr_b16 a[6:7], v250 offset:2056
    v_mfma_f32_16x16x32_bf16 v[108:111], v[204:207], v[212:215], v[108:111]
    ds_read_b64_tr_b16 a[8:9], v251 offset:0
    ds_read_b64_tr_b16 a[10:11], v251 offset:2048
    v_mfma_f32_16x16x32_bf16 v[124:127], v[204:207], v[216:219], v[124:127]
    ds_read_b64_tr_b16 a[12:13], v251 offset:8
    ds_read_b64_tr_b16 a[14:15], v251 offset:2056
    v_mfma_f32_16x16x32_bf16 v[140:143], v[204:207], v[220:223], v[140:143]
    v_mfma_f32_16x16x32_bf16 v[156:159], v[204:207], v[224:227], v[156:159]
    v_mfma_f32_16x16x32_bf16 v[112:115], v[208:211], v[212:215], v[112:115]
    buffer_load_dwordx4 v247, s[12:15], s75 offen offset:1024 lds
    v_mfma_f32_16x16x32_bf16 v[128:131], v[208:211], v[216:219], v[128:131]
    v_mfma_f32_16x16x32_bf16 v[144:147], v[208:211], v[220:223], v[144:147]
    v_mfma_f32_16x16x32_bf16 v[160:163], v[208:211], v[224:227], v[160:163]
    s_waitcnt lgkmcnt(8)
    v_mfma_f32_16x16x16_bf16 v[100:103], v[68:69], v[52:53], v[100:103]
    v_mfma_f32_16x16x16_bf16 v[104:107], v[70:71], v[52:53], v[104:107]
    v_mfma_f32_16x16x16_bf16 v[108:111], v[72:73], v[52:53], v[108:111]
    v_mfma_f32_16x16x16_bf16 v[112:115], v[74:75], v[52:53], v[112:115]
    v_mfma_f32_16x16x16_bf16 v[116:119], v[68:69], v[56:57], v[116:119]
    v_mfma_f32_16x16x16_bf16 v[120:123], v[70:71], v[56:57], v[120:123]
    v_mfma_f32_16x16x16_bf16 v[124:127], v[72:73], v[56:57], v[124:127]
    v_mfma_f32_16x16x16_bf16 v[128:131], v[74:75], v[56:57], v[128:131]
    v_mfma_f32_16x16x16_bf16 v[132:135], v[68:69], v[60:61], v[132:135]
    v_mfma_f32_16x16x16_bf16 v[136:139], v[70:71], v[60:61], v[136:139]
    v_mfma_f32_16x16x16_bf16 v[140:143], v[72:73], v[60:61], v[140:143]
    v_mfma_f32_16x16x16_bf16 v[144:147], v[74:75], v[60:61], v[144:147]
    v_mfma_f32_16x16x16_bf16 v[148:151], v[68:69], v[64:65], v[148:151]
    v_mfma_f32_16x16x16_bf16 v[152:155], v[70:71], v[64:65], v[152:155]
    v_mfma_f32_16x16x16_bf16 v[156:159], v[72:73], v[64:65], v[156:159]
    v_mfma_f32_16x16x16_bf16 v[160:163], v[74:75], v[64:65], v[160:163]
    s_lshl_b32 s31, s70, 1
    s_and_b32 s32, s28, 1
    s_add_u32 s33, s31, s32
    s_mul_i32 s31, s33, 229376
    s_lshl_b32 s32, s71, 2
    s_and_b32 s34, s28, 2
    s_add_u32 s34, s32, s34
    s_lshl_b32 s32, s34, 10
    s_add_u32 s31, s31, s32
    s_lshl_b32 s33, s33, 9
    s_lshl_b32 s34, s34, 1
    s_add_u32 s70, s33, s34
    s_add_u32 s70, s70, 0xb01000
    s_mul_i32 s34, s34, 37
    s_lshr_b32 s34, s34, 10
    s_lshl_b32 s34, s34, 7
    s_add_u32 s70, s70, s34
    v_pk_mul_f32 v[100:101], v[100:101], v[54:55] op_sel_hi:[1,0]
    v_pk_mul_f32 v[102:103], v[102:103], v[54:55] op_sel_hi:[1,0]
    v_max_f32 v100, 0, v100
    v_max_f32 v101, 0, v101
    v_max_f32 v102, 0, v102
    v_max_f32 v103, 0, v103
    v_pk_mul_f32 v[100:101], v[100:101], v[100:101]
    v_pk_mul_f32 v[102:103], v[102:103], v[102:103]
    v_cvt_pk_bf16_f32 v164, v100, v101
    v_cvt_pk_bf16_f32 v165, v102, v103
    v_pk_mul_f32 v[104:105], v[104:105], v[54:55] op_sel_hi:[1,0]
    v_pk_mul_f32 v[106:107], v[106:107], v[54:55] op_sel_hi:[1,0]
    v_max_f32 v104, 0, v104
    v_max_f32 v105, 0, v105
    v_max_f32 v106, 0, v106
    v_max_f32 v107, 0, v107
    v_pk_mul_f32 v[104:105], v[104:105], v[104:105]
    v_pk_mul_f32 v[106:107], v[106:107], v[106:107]
    v_cvt_pk_bf16_f32 v166, v104, v105
    v_cvt_pk_bf16_f32 v167, v106, v107
    buffer_store_dwordx4 v[164:167], v6, s[16:19], s31 offen offset:0 sc1
    v_pk_mul_f32 v[108:109], v[108:109], v[54:55] op_sel_hi:[1,0]
    v_pk_mul_f32 v[110:111], v[110:111], v[54:55] op_sel_hi:[1,0]
    v_max_f32 v108, 0, v108
    v_max_f32 v109, 0, v109
    v_max_f32 v110, 0, v110
    v_max_f32 v111, 0, v111
    v_pk_mul_f32 v[108:109], v[108:109], v[108:109]
    v_pk_mul_f32 v[110:111], v[110:111], v[110:111]
    v_cvt_pk_bf16_f32 v168, v108, v109
    v_cvt_pk_bf16_f32 v169, v110, v111
    v_pk_mul_f32 v[112:113], v[112:113], v[54:55] op_sel_hi:[1,0]
    v_pk_mul_f32 v[114:115], v[114:115], v[54:55] op_sel_hi:[1,0]
    v_max_f32 v112, 0, v112
    v_max_f32 v113, 0, v113
    v_max_f32 v114, 0, v114
    v_max_f32 v115, 0, v115
    v_pk_mul_f32 v[112:113], v[112:113], v[112:113]
    v_pk_mul_f32 v[114:115], v[114:115], v[114:115]
    v_cvt_pk_bf16_f32 v170, v112, v113
    v_cvt_pk_bf16_f32 v171, v114, v115
    buffer_store_dwordx4 v[168:171], v6, s[16:19], s31 offen offset:1024 sc1
    s_add_u32 s31, s31, 57344
    v_pk_mul_f32 v[116:117], v[116:117], v[58:59] op_sel_hi:[1,0]
    v_pk_mul_f32 v[118:119], v[118:119], v[58:59] op_sel_hi:[1,0]
    v_max_f32 v116, 0, v116
    v_max_f32 v117, 0, v117
    v_max_f32 v118, 0, v118
    v_max_f32 v119, 0, v119
    v_pk_mul_f32 v[116:117], v[116:117], v[116:117]
    v_pk_mul_f32 v[118:119], v[118:119], v[118:119]
    v_cvt_pk_bf16_f32 v172, v116, v117
    v_cvt_pk_bf16_f32 v173, v118, v119
    v_pk_mul_f32 v[120:121], v[120:121], v[58:59] op_sel_hi:[1,0]
    v_pk_mul_f32 v[122:123], v[122:123], v[58:59] op_sel_hi:[1,0]
    v_max_f32 v120, 0, v120
    v_max_f32 v121, 0, v121
    v_max_f32 v122, 0, v122
    v_max_f32 v123, 0, v123
    v_pk_mul_f32 v[120:121], v[120:121], v[120:121]
    v_pk_mul_f32 v[122:123], v[122:123], v[122:123]
    v_cvt_pk_bf16_f32 v174, v120, v121
    v_cvt_pk_bf16_f32 v175, v122, v123
    buffer_store_dwordx4 v[172:175], v6, s[16:19], s31 offen offset:0 sc1
    v_pk_mul_f32 v[124:125], v[124:125], v[58:59] op_sel_hi:[1,0]
    v_pk_mul_f32 v[126:127], v[126:127], v[58:59] op_sel_hi:[1,0]
    v_max_f32 v124, 0, v124
    v_max_f32 v125, 0, v125
    v_max_f32 v126, 0, v126
    v_max_f32 v127, 0, v127
    v_pk_mul_f32 v[124:125], v[124:125], v[124:125]
    v_pk_mul_f32 v[126:127], v[126:127], v[126:127]
    v_cvt_pk_bf16_f32 v176, v124, v125
    v_cvt_pk_bf16_f32 v177, v126, v127
    v_pk_mul_f32 v[128:129], v[128:129], v[58:59] op_sel_hi:[1,0]
    v_pk_mul_f32 v[130:131], v[130:131], v[58:59] op_sel_hi:[1,0]
    v_max_f32 v128, 0, v128
    v_max_f32 v129, 0, v129
    v_max_f32 v130, 0, v130
    v_max_f32 v131, 0, v131
    v_pk_mul_f32 v[128:129], v[128:129], v[128:129]
    v_pk_mul_f32 v[130:131], v[130:131], v[130:131]
    v_cvt_pk_bf16_f32 v178, v128, v129
    v_cvt_pk_bf16_f32 v179, v130, v131
    buffer_store_dwordx4 v[176:179], v6, s[16:19], s31 offen offset:1024 sc1
    s_add_u32 s31, s31, 57344
    v_pk_mul_f32 v[132:133], v[132:133], v[62:63] op_sel_hi:[1,0]
    v_pk_mul_f32 v[134:135], v[134:135], v[62:63] op_sel_hi:[1,0]
    v_max_f32 v132, 0, v132
    v_max_f32 v133, 0, v133
    v_max_f32 v134, 0, v134
    v_max_f32 v135, 0, v135
    s_mov_b32 s35, 98304
    v_and_b32_e64 v44, 1, v0
    v_mul_u32_u24 v44, 16696, v44
    v_lshl_add_u32 v44, v0, 3, v44
    v_add_u32 v44, 98336, v44
    v_bfe_u32 v46, v0, 3, 2
    v_mul_u32_u24 v46, 4160, v46
    v_pk_mul_f32 v[132:133], v[132:133], v[132:133]
    v_pk_mul_f32 v[134:135], v[134:135], v[134:135]
    v_cvt_pk_bf16_f32 v180, v132, v133
    v_cvt_pk_bf16_f32 v181, v134, v135
    v_pk_mul_f32 v[136:137], v[136:137], v[62:63] op_sel_hi:[1,0]
    v_pk_mul_f32 v[138:139], v[138:139], v[62:63] op_sel_hi:[1,0]
    v_max_f32 v136, 0, v136
    v_max_f32 v137, 0, v137
    v_max_f32 v138, 0, v138
    v_max_f32 v139, 0, v139
    v_and_b32_e64 v47, 7, v1
    v_lshl_add_u32 v46, v47, 2, v46
    v_bfe_u32 v47, v0, 5, 1
    v_mul_u32_u24 v47, 16704, v47
    v_add3_u32 v46, v46, v47, s35
    v_mov_b32_e64 v47, 0
    ds_write_b32 v46, v47
    v_pk_mul_f32 v[136:137], v[136:137], v[136:137]
    v_pk_mul_f32 v[138:139], v[138:139], v[138:139]
    v_cvt_pk_bf16_f32 v182, v136, v137
    v_cvt_pk_bf16_f32 v183, v138, v139
    buffer_store_dwordx4 v[180:183], v6, s[16:19], s31 offen offset:0 sc1
    v_pk_mul_f32 v[140:141], v[140:141], v[62:63] op_sel_hi:[1,0]
    v_pk_mul_f32 v[142:143], v[142:143], v[62:63] op_sel_hi:[1,0]
    v_max_f32 v140, 0, v140
    v_max_f32 v141, 0, v141
    v_max_f32 v142, 0, v142
    v_max_f32_e64 v143, 0, v143
    s_waitcnt vmcnt(11)
    ds_write_b128 v44, v[232:235] offset:0
    v_mov_b32_dpp v230, v234 row_shr:2 row_mask:0xf bank_mask:0xf
    v_mov_b32_dpp v231, v235 row_shr:2 row_mask:0xf bank_mask:0xf
    v_alignbit_b32 v196, v232, v231, 16
    v_alignbit_b32 v197, v233, v232, 16
    v_alignbit_b32 v198, v234, v233, 16
    v_pk_mul_f32 v[140:141], v[140:141], v[140:141]
    v_pk_mul_f32 v[142:143], v[142:143], v[142:143]
    v_cvt_pk_bf16_f32 v184, v140, v141
    v_cvt_pk_bf16_f32 v185, v142, v143
    v_pk_mul_f32 v[144:145], v[144:145], v[62:63] op_sel_hi:[1,0]
    v_pk_mul_f32 v[146:147], v[146:147], v[62:63] op_sel_hi:[1,0]
    v_max_f32 v144, 0, v144
    v_max_f32 v145, 0, v145
    v_max_f32 v146, 0, v146
    v_max_f32 v147, 0, v147
    v_alignbit_b32 v199, v235, v234, 16
    ds_write_b128 v44, v[196:199] offset:4160
    v_pk_mov_b32 v[200:201], v[230:231], v[232:233] op_sel:[1,0]
    v_pk_mov_b32 v[202:203], v[232:233], v[234:235] op_sel:[1,0]
    ds_write_b128 v44, v[200:203] offset:8320
    v_alignbit_b32 v204, v231, v230, 16
    v_alignbit_b32 v205, v232, v231, 16
    v_pk_mul_f32 v[144:145], v[144:145], v[144:145]
    v_pk_mul_f32 v[146:147], v[146:147], v[146:147]
    v_cvt_pk_bf16_f32 v186, v144, v145
    v_cvt_pk_bf16_f32 v187, v146, v147
    buffer_store_dwordx4 v[184:187], v6, s[16:19], s31 offen offset:1024 sc1
    s_add_u32 s31, s31, 57344
    v_pk_mul_f32 v[148:149], v[148:149], v[66:67] op_sel_hi:[1,0]
    v_pk_mul_f32 v[150:151], v[150:151], v[66:67] op_sel_hi:[1,0]
    v_max_f32 v148, 0, v148
    v_max_f32 v149, 0, v149
    v_max_f32 v150, 0, v150
    v_max_f32 v151, 0, v151
    v_alignbit_b32 v206, v233, v232, 16
    v_alignbit_b32 v207, v234, v233, 16
    ds_write_b128 v44, v[204:207] offset:12480
    ds_write_b128 v44, v[240:243] offset:2048
    v_mov_b32_dpp v238, v242 row_shr:2 row_mask:0xf bank_mask:0xf
    v_mov_b32_dpp v239, v243 row_shr:2 row_mask:0xf bank_mask:0xf
    v_alignbit_b32 v208, v240, v239, 16
    v_pk_mul_f32 v[148:149], v[148:149], v[148:149]
    v_pk_mul_f32 v[150:151], v[150:151], v[150:151]
    v_cvt_pk_bf16_f32 v188, v148, v149
    v_cvt_pk_bf16_f32 v189, v150, v151
    v_pk_mul_f32 v[152:153], v[152:153], v[66:67] op_sel_hi:[1,0]
    v_pk_mul_f32 v[154:155], v[154:155], v[66:67] op_sel_hi:[1,0]
    v_max_f32 v152, 0, v152
    v_max_f32 v153, 0, v153
    v_max_f32 v154, 0, v154
    v_max_f32 v155, 0, v155
    v_alignbit_b32 v209, v241, v240, 16
    v_alignbit_b32 v210, v242, v241, 16
    v_alignbit_b32 v211, v243, v242, 16
    ds_write_b128 v44, v[208:211] offset:6208
    v_pk_mov_b32 v[212:213], v[238:239], v[240:241] op_sel:[1,0]
    v_pk_mov_b32 v[214:215], v[240:241], v[242:243] op_sel:[1,0]
    ds_write_b128 v44, v[212:215] offset:10368
    v_pk_mul_f32 v[152:153], v[152:153], v[152:153]
    v_pk_mul_f32 v[154:155], v[154:155], v[154:155]
    v_cvt_pk_bf16_f32 v190, v152, v153
    v_cvt_pk_bf16_f32 v191, v154, v155
    buffer_store_dwordx4 v[188:191], v6, s[16:19], s31 offen offset:0 sc1
    v_pk_mul_f32 v[156:157], v[156:157], v[66:67] op_sel_hi:[1,0]
    v_pk_mul_f32 v[158:159], v[158:159], v[66:67] op_sel_hi:[1,0]
    v_max_f32 v156, 0, v156
    v_max_f32 v157, 0, v157
    v_max_f32 v158, 0, v158
    v_max_f32 v159, 0, v159
    v_alignbit_b32 v216, v239, v238, 16
    v_alignbit_b32 v217, v240, v239, 16
    v_alignbit_b32 v218, v241, v240, 16
    v_alignbit_b32 v219, v242, v241, 16
    ds_write_b128 v44, v[216:219] offset:14528
    v_pk_mul_f32 v[156:157], v[156:157], v[156:157]
    v_pk_mul_f32 v[158:159], v[158:159], v[158:159]
    v_cvt_pk_bf16_f32 v192, v156, v157
    v_cvt_pk_bf16_f32 v193, v158, v159
    v_pk_mul_f32 v[160:161], v[160:161], v[66:67] op_sel_hi:[1,0]
    v_pk_mul_f32 v[162:163], v[162:163], v[66:67] op_sel_hi:[1,0]
    v_max_f32 v160, 0, v160
    v_max_f32 v161, 0, v161
    v_max_f32 v162, 0, v162
    v_max_f32 v163, 0, v163
    v_pk_mul_f32 v[160:161], v[160:161], v[160:161]
    v_pk_mul_f32 v[162:163], v[162:163], v[162:163]
    v_cvt_pk_bf16_f32 v194, v160, v161
    v_cvt_pk_bf16_f32 v195, v162, v163
    buffer_store_dwordx4 v[192:195], v6, s[16:19], s31 offen offset:1024 sc1
    buffer_load_dwordx4 v248, s[12:15], s75 offen offset:2048 lds
    buffer_load_dwordx4 v249, s[12:15], s75 offen offset:3072 lds
    s_add_u32 s75, s75, 32768
    s_cmp_eq_u32 s75, s25
    s_cselect_b32 s27, 458752, 0
    s_sub_u32 s75, s75, s27
JOIN_3:
    s_waitcnt lgkmcnt(0)
    s_barrier
    ds_read_b128 v[124:127], v9 offset:192
    ds_read_b64_tr_b16 v[172:173], v8 offset:8
    ds_read_b64_tr_b16 v[174:175], v8 offset:0
    ds_read_b128 v[128:131], v9 offset:704
    ds_read_b64_tr_b16 v[176:177], v8 offset:520
    ds_read_b64_tr_b16 v[178:179], v8 offset:512
    ds_read_b128 v[132:135], v9 offset:1216
    ds_read_b64_tr_b16 v[180:181], v8 offset:1032
    ds_read_b64_tr_b16 v[182:183], v8 offset:1024
    ds_read_b128 v[136:139], v9 offset:1728
    ds_read_b64_tr_b16 v[184:185], v8 offset:1544
    ds_read_b64_tr_b16 v[186:187], v8 offset:1536
    s_waitcnt lgkmcnt(9)
    v_mfma_f32_16x16x32_bf16 a[224:227], v[172:175], v[124:127], 0
    ds_read_b128 v[140:143], v9 offset:2240
    ds_read_b64_tr_b16 v[188:189], v8 offset:2056
    ds_read_b64_tr_b16 v[190:191], v8 offset:2048
    s_waitcnt lgkmcnt(9)
    v_mfma_f32_16x16x32_bf16 a[228:231], v[176:179], v[124:127], 0
    ds_read_b128 v[144:147], v9 offset:2752
    v_mfma_f32_16x16x32_bf16 a[228:231], v[172:175], v[128:131], a[228:231]
    buffer_load_dwordx4 v[108:111], v11, s[4:7], 0 offen offset:0
    ds_read_b64_tr_b16 v[192:193], v8 offset:2568
    v_mfma_f32_16x16x32_bf16 a[232:235], v[176:179], v[128:131], 0
    ds_read_b64_tr_b16 v[194:195], v8 offset:2560
    s_waitcnt lgkmcnt(9)
    v_mfma_f32_16x16x32_bf16 a[232:235], v[180:183], v[124:127], a[232:235]
    ds_read_b128 v[148:151], v9 offset:3264
    v_mfma_f32_16x16x32_bf16 a[236:239], v[180:183], v[128:131], 0
    global_load_dwordx4 v[116:119], v12, s[62:63] offset:0
    ds_read_b64_tr_b16 v[196:197], v8 offset:3080
    v_mfma_f32_16x16x32_bf16 a[232:235], v[172:175], v[132:135], a[232:235]
    ds_read_b64_tr_b16 v[198:199], v8 offset:3072
    v_mfma_f32_16x16x32_bf16 a[236:239], v[176:179], v[132:135], a[236:239]
    ds_read_b64_tr_b16 a[16:17], v250 offset:4096
    ds_read_b64_tr_b16 a[18:19], v250 offset:6144
    v_mfma_f32_16x16x32_bf16 a[240:243], v[180:183], v[132:135], 0
    buffer_load_dwordx4 v[112:115], v11, s[4:7], 0 offen offset:64
    ds_read_b64_tr_b16 a[20:21], v250 offset:4104
    ds_read_b64_tr_b16 a[22:23], v250 offset:6152
    s_waitcnt lgkmcnt(13)
    v_mfma_f32_16x16x32_bf16 a[236:239], v[184:187], v[124:127], a[236:239]
    ds_read_b128 v[152:155], v9 offset:3776
    v_mfma_f32_16x16x32_bf16 a[240:243], v[184:187], v[128:131], a[240:243]
    ds_read_b64_tr_b16 v[200:201], v8 offset:3592
    v_mfma_f32_16x16x32_bf16 a[244:247], v[184:187], v[132:135], 0
    global_load_dwordx4 v[120:123], v12, s[62:63] offset:64
    ds_read_b64_tr_b16 v[202:203], v8 offset:3584
    v_mfma_f32_16x16x32_bf16 a[236:239], v[172:175], v[136:139], a[236:239]
    ds_read_b64_tr_b16 a[24:25], v251 offset:4096
    ds_read_b64_tr_b16 a[26:27], v251 offset:6144
    v_mfma_f32_16x16x32_bf16 a[240:243], v[176:179], v[136:139], a[240:243]
    ds_read_b64_tr_b16 a[28:29], v251 offset:4104
    ds_read_b64_tr_b16 a[30:31], v251 offset:6152
    v_mfma_f32_16x16x32_bf16 a[244:247], v[180:183], v[136:139], a[244:247]
    s_add_u32 m0, s3, 65536
    s_nop 0
    buffer_load_dwordx4 v246, s[12:15], s75 offen offset:0 lds
    v_mfma_f32_16x16x32_bf16 a[248:251], v[184:187], v[136:139], 0
    s_waitcnt vmcnt(7)
    v_lshlrev_b32 v16, 26, v1
    v_mov_b32 v17, s54
    buffer_store_dword v17, v16, s[16:19], s70 offen sc1
    s_waitcnt lgkmcnt(15)
    v_mfma_f32_16x16x32_bf16 a[240:243], v[188:191], v[124:127], a[240:243]
    ds_read_b128 v[156:159], v9 offset:128
    v_mfma_f32_16x16x32_bf16 a[244:247], v[188:191], v[128:131], a[244:247]
    buffer_load_dwordx4 v247, s[12:15], s75 offen offset:1024 lds
    ds_read_b64_tr_b16 v[204:205], v8 offset:72
    v_mfma_f32_16x16x32_bf16 a[248:251], v[188:191], v[132:135], a[248:251]
    ds_read_b64_tr_b16 v[206:207], v8 offset:64
    v_mfma_f32_16x16x32_bf16 a[252:255], v[188:191], v[136:139], 0
    v_mfma_f32_16x16x32_bf16 a[240:243], v[172:175], v[140:143], a[240:243]
    buffer_load_dwordx4 v248, s[12:15], s75 offen offset:2048 lds
    v_mfma_f32_16x16x32_bf16 a[244:247], v[176:179], v[140:143], a[244:247]
    v_mfma_f32_16x16x32_bf16 a[248:251], v[180:183], v[140:143], a[248:251]
    v_mfma_f32_16x16x32_bf16 a[252:255], v[184:187], v[140:143], a[252:255]
    buffer_load_dwordx4 v249, s[12:15], s75 offen offset:3072 lds
    s_add_u32 s75, s75, 32768
    s_cmp_eq_u32 s75, s25
    s_cselect_b32 s27, 458752, 0
    s_sub_u32 s75, s75, s27
    s_waitcnt lgkmcnt(15)
    v_mfma_f32_16x16x32_bf16 a[244:247], v[192:195], v[124:127], a[244:247]
    ds_read_b128 v[160:163], v9 offset:640
    v_mfma_f32_16x16x32_bf16 a[248:251], v[192:195], v[128:131], a[248:251]
    ds_read_b64_tr_b16 v[208:209], v8 offset:584
    v_mfma_f32_16x16x32_bf16 a[252:255], v[192:195], v[132:135], a[252:255]
    s_add_u32 m0, s3, 69632
    s_nop 0
    buffer_load_dwordx4 v246, s[12:15], s75 offen offset:0 lds
    ds_read_b64_tr_b16 v[210:211], v8 offset:576
    v_mfma_f32_16x16x32_bf16 a[244:247], v[172:175], v[144:147], a[244:247]
    v_mfma_f32_16x16x32_bf16 a[248:251], v[176:179], v[144:147], a[248:251]
    v_mfma_f32_16x16x32_bf16 a[252:255], v[180:183], v[144:147], a[252:255]
    buffer_load_dwordx4 v247, s[12:15], s75 offen offset:1024 lds
    ds_read_b64_tr_b16 a[32:33], v250 offset:32768
    ds_read_b64_tr_b16 a[34:35], v250 offset:34816
    s_waitcnt lgkmcnt(15)
    v_mfma_f32_16x16x32_bf16 a[248:251], v[196:199], v[124:127], a[248:251]
    ds_read_b128 v[164:167], v9 offset:1152
    v_mfma_f32_16x16x32_bf16 a[252:255], v[196:199], v[128:131], a[252:255]
    ds_read_b64_tr_b16 v[212:213], v8 offset:1096
    v_mfma_f32_16x16x32_bf16 a[248:251], v[172:175], v[148:151], a[248:251]
    buffer_load_dwordx4 v248, s[12:15], s75 offen offset:2048 lds
    ds_read_b64_tr_b16 v[214:215], v8 offset:1088
    v_mfma_f32_16x16x32_bf16 a[252:255], v[176:179], v[148:151], a[252:255]
    ds_read_b64_tr_b16 a[36:37], v250 offset:32776
    ds_read_b64_tr_b16 a[38:39], v250 offset:34824
    s_waitcnt lgkmcnt(15)
    v_mfma_f32_16x16x32_bf16 a[252:255], v[200:203], v[124:127], a[252:255]
    ds_read_b128 v[168:171], v9 offset:1664
    v_mfma_f32_16x16x32_bf16 a[252:255], v[172:175], v[152:155], a[252:255]
    buffer_load_dwordx4 v249, s[12:15], s75 offen offset:3072 lds
    s_add_u32 s75, s75, 32768
    s_cmp_eq_u32 s75, s25
    s_cselect_b32 s27, 458752, 0
    s_sub_u32 s75, s75, s27
    ds_read_b64_tr_b16 v[216:217], v8 offset:1608
    ds_read_b64_tr_b16 v[218:219], v8 offset:1600
    s_waitcnt lgkmcnt(13)
    v_mfma_f32_16x16x32_bf16 a[224:227], v[204:207], v[156:159], a[224:227]
    ds_read_b128 v[124:127], v9 offset:2176
    ds_read_b64_tr_b16 v[172:173], v8 offset:2120
    ds_read_b64_tr_b16 v[174:175], v8 offset:2112
    s_waitcnt lgkmcnt(13)
    v_mfma_f32_16x16x32_bf16 a[228:231], v[208:211], v[156:159], a[228:231]
    ds_read_b128 v[128:131], v9 offset:2688
    v_mfma_f32_16x16x32_bf16 a[228:231], v[204:207], v[160:163], a[228:231]
    s_add_u32 m0, s3, 0
    s_nop 0
    buffer_load_dwordx4 v246, s[12:15], s75 offen offset:0 lds
    ds_read_b64_tr_b16 v[176:177], v8 offset:2632
    v_mfma_f32_16x16x32_bf16 a[232:235], v[208:211], v[160:163], a[232:235]
    ds_read_b64_tr_b16 v[178:179], v8 offset:2624
    s_waitcnt lgkmcnt(11)
    v_mfma_f32_16x16x32_bf16 a[232:235], v[212:215], v[156:159], a[232:235]
    ds_read_b128 v[132:135], v9 offset:3200
    v_mfma_f32_16x16x32_bf16 a[236:239], v[212:215], v[160:163], a[236:239]
    buffer_load_dwordx4 v247, s[12:15], s75 offen offset:1024 lds
    ds_read_b64_tr_b16 v[180:181], v8 offset:3144
    v_mfma_f32_16x16x32_bf16 a[232:235], v[204:207], v[164:167], a[232:235]
    ds_read_b64_tr_b16 v[182:183], v8 offset:3136
    v_mfma_f32_16x16x32_bf16 a[236:239], v[208:211], v[164:167], a[236:239]
    ds_read_b64_tr_b16 a[40:41], v251 offset:32768
    ds_read_b64_tr_b16 a[42:43], v251 offset:34816
    v_mfma_f32_16x16x32_bf16 a[240:243], v[212:215], v[164:167], a[240:243]
    buffer_load_dwordx4 v248, s[12:15], s75 offen offset:2048 lds
    ds_read_b64_tr_b16 a[44:45], v251 offset:32776
    ds_read_b64_tr_b16 a[46:47], v251 offset:34824
    s_waitcnt lgkmcnt(13)
    v_mfma_f32_16x16x32_bf16 a[236:239], v[216:219], v[156:159], a[236:239]
    ds_read_b128 v[136:139], v9 offset:3712
    v_mfma_f32_16x16x32_bf16 a[240:243], v[216:219], v[160:163], a[240:243]
    ds_read_b64_tr_b16 v[184:185], v8 offset:3656
    v_mfma_f32_16x16x32_bf16 a[244:247], v[216:219], v[164:167], a[244:247]
    buffer_load_dwordx4 v249, s[12:15], s75 offen offset:3072 lds
    s_add_u32 s75, s75, 32768
    s_cmp_eq_u32 s75, s25
    s_cselect_b32 s27, 458752, 0
    s_sub_u32 s75, s75, s27
    ds_read_b64_tr_b16 v[186:187], v8 offset:3648
    v_mfma_f32_16x16x32_bf16 a[236:239], v[204:207], v[168:171], a[236:239]
    s_waitcnt vmcnt(17)
    ds_read_b64_tr_b16 a[48:49], v250 offset:36864
    ds_read_b64_tr_b16 a[50:51], v250 offset:38912
    v_mfma_f32_16x16x32_bf16 a[240:243], v[208:211], v[168:171], a[240:243]
    ds_read_b64_tr_b16 a[52:53], v250 offset:36872
    ds_read_b64_tr_b16 a[54:55], v250 offset:38920
    v_mfma_f32_16x16x32_bf16 a[244:247], v[212:215], v[168:171], a[244:247]
    s_add_u32 m0, s3, 4096
    s_nop 0
    buffer_load_dwordx4 v246, s[12:15], s75 offen offset:0 lds
    ds_read_b64_tr_b16 a[56:57], v251 offset:36864
    ds_read_b64_tr_b16 a[58:59], v251 offset:38912
    v_mfma_f32_16x16x32_bf16 a[248:251], v[216:219], v[168:171], a[248:251]
    ds_read_b64_tr_b16 a[60:61], v251 offset:36872
    ds_read_b64_tr_b16 a[62:63], v251 offset:38920
    s_waitcnt lgkmcnt(15)
    v_mfma_f32_16x16x32_bf16 a[240:243], v[172:175], v[156:159], a[240:243]
    ds_read_b128 v[140:143], v9 offset:64
    v_mfma_f32_16x16x32_bf16 a[244:247], v[172:175], v[160:163], a[244:247]
    buffer_load_dwordx4 v247, s[12:15], s75 offen offset:1024 lds
    ds_read_b64_tr_b16 v[188:189], v8 offset:136
    v_mfma_f32_16x16x32_bf16 a[248:251], v[172:175], v[164:167], a[248:251]
    ds_read_b64_tr_b16 v[190:191], v8 offset:128
    v_mfma_f32_16x16x32_bf16 a[252:255], v[172:175], v[168:171], a[252:255]
    v_mfma_f32_16x16x32_bf16 a[240:243], v[204:207], v[124:127], a[240:243]
    buffer_load_dwordx4 v248, s[12:15], s75 offen offset:2048 lds
    v_mfma_f32_16x16x32_bf16 a[244:247], v[208:211], v[124:127], a[244:247]
    v_mfma_f32_16x16x32_bf16 a[248:251], v[212:215], v[124:127], a[248:251]
    v_mfma_f32_16x16x32_bf16 a[252:255], v[216:219], v[124:127], a[252:255]
    buffer_load_dwordx4 v249, s[12:15], s75 offen offset:3072 lds
    s_add_u32 s75, s75, 32768
    s_cmp_eq_u32 s75, s25
    s_cselect_b32 s27, 458752, 0
    s_sub_u32 s75, s75, s27
    v_mfma_f32_16x16x32_bf16 a[244:247], v[176:179], v[156:159], a[244:247]
    ds_read_b128 v[144:147], v9 offset:576
    s_waitcnt vmcnt(17)
    v_mfma_f32_16x16x32_bf16 a[248:251], v[176:179], v[160:163], a[248:251]
    ds_read_b64_tr_b16 v[192:193], v8 offset:648
    v_lshlrev_b32 v28, 16, v108
    v_mfma_f32_16x16x32_bf16 a[252:255], v[176:179], v[164:167], a[252:255]
    s_waitcnt lgkmcnt(15)
    s_add_u32 m0, s3, 32768
    s_nop 0
    buffer_load_dwordx4 v246, s[12:15], s75 offen offset:0 lds
    ds_read_b64_tr_b16 v[194:195], v8 offset:640
    v_and_b32 v29, 0xffff0000, v108
    v_mfma_f32_16x16x32_bf16 a[244:247], v[204:207], v[128:131], a[244:247]
    v_lshlrev_b32_e64 v16, 16, v116
    v_mfma_f32_16x16x32_bf16 a[248:251], v[208:211], v[128:131], a[248:251]
    v_and_b32 v17, 0xffff0000, v116
    v_mfma_f32_16x16x32_bf16 a[252:255], v[212:215], v[128:131], a[252:255]
    buffer_load_dwordx4 v247, s[12:15], s75 offen offset:1024 lds
    s_waitcnt vmcnt(14)
    ds_read_b64_tr_b16 a[64:65], v252 offset:0
    ds_read_b64_tr_b16 a[66:67], v252 offset:2048
    v_add_f32 v28, v28, v16
    v_mfma_f32_16x16x32_bf16 a[248:251], v[180:183], v[156:159], a[248:251]
    ds_read_b128 v[148:151], v9 offset:1088
    v_add_f32_e64 v29, v29, v17
    v_mfma_f32_16x16x32_bf16 a[252:255], v[180:183], v[160:163], a[252:255]
    ds_read_b64_tr_b16 v[196:197], v8 offset:1160
    v_lshlrev_b32_e64 v30, 16, v109
    v_mfma_f32_16x16x32_bf16 a[248:251], v[204:207], v[132:135], a[248:251]
    buffer_load_dwordx4 v248, s[12:15], s75 offen offset:2048 lds
    ds_read_b64_tr_b16 v[198:199], v8 offset:1152
    v_and_b32 v31, 0xffff0000, v109
    v_mfma_f32_16x16x32_bf16 a[252:255], v[208:211], v[132:135], a[252:255]
    ds_read_b64_tr_b16 a[68:69], v252 offset:8
    ds_read_b64_tr_b16 a[70:71], v252 offset:2056
    v_lshlrev_b32 v16, 16, v117
    s_waitcnt lgkmcnt(15)
    v_mfma_f32_16x16x32_bf16 a[252:255], v[184:187], v[156:159], a[252:255]
    ds_read_b128 v[152:155], v9 offset:1600
    v_and_b32 v17, 0xffff0000, v117
    v_mfma_f32_16x16x32_bf16 a[252:255], v[204:207], v[136:139], a[252:255]
    buffer_load_dwordx4 v249, s[12:15], s75 offen offset:3072 lds
    s_add_u32 s75, s75, 32768
    s_cmp_eq_u32 s75, s25
    s_cselect_b32 s27, 458752, 0
    s_sub_u32 s75, s75, s27
    ds_read_b64_tr_b16 v[200:201], v8 offset:1672
    v_add_f32_e64 v30, v30, v16
    ds_read_b64_tr_b16 v[202:203], v8 offset:1664
    s_waitcnt lgkmcnt(13)
    v_mfma_f32_16x16x32_bf16 a[224:227], v[188:191], v[140:143], a[224:227]
    ds_read_b128 v[156:159], v9 offset:2112
    v_add_f32 v31, v31, v17
    ds_read_b64_tr_b16 v[204:205], v8 offset:2184
    ds_read_b64_tr_b16 v[206:207], v8 offset:2176
    s_waitcnt lgkmcnt(13)
    v_mfma_f32_16x16x32_bf16 a[228:231], v[192:195], v[140:143], a[228:231]
    ds_read_b128 v[160:163], v9 offset:2624
    v_lshlrev_b32 v32, 16, v110
    v_mfma_f32_16x16x32_bf16 a[228:231], v[188:191], v[144:147], a[228:231]
    s_add_u32 m0, s3, 36864
    s_nop 0
    buffer_load_dwordx4 v246, s[12:15], s75 offen offset:0 lds
    ds_read_b64_tr_b16 v[208:209], v8 offset:2696
    s_nop 0
    v_and_b32 v33, 0xffff0000, v110
    v_mfma_f32_16x16x32_bf16 a[232:235], v[192:195], v[144:147], a[232:235]
    ds_read_b64_tr_b16 v[210:211], v8 offset:2688
    v_lshlrev_b32 v16, 16, v118
    s_waitcnt lgkmcnt(11)
    v_mfma_f32_16x16x32_bf16 a[232:235], v[196:199], v[140:143], a[232:235]
    ds_read_b128 v[164:167], v9 offset:3136
    v_and_b32 v17, 0xffff0000, v118
    v_mfma_f32_16x16x32_bf16 a[236:239], v[196:199], v[144:147], a[236:239]
    buffer_load_dwordx4 v247, s[12:15], s75 offen offset:1024 lds
    ds_read_b64_tr_b16 v[212:213], v8 offset:3208
    v_add_f32_e64 v32, v32, v16
    v_mfma_f32_16x16x32_bf16 a[232:235], v[188:191], v[148:151], a[232:235]
    ds_read_b64_tr_b16 v[214:215], v8 offset:3200
    v_add_f32_e64 v33, v33, v17
    v_mfma_f32_16x16x32_bf16 a[236:239], v[192:195], v[148:151], a[236:239]
    ds_read_b64_tr_b16 a[72:73], v253 offset:0
    ds_read_b64_tr_b16 a[74:75], v253 offset:2048
    v_lshlrev_b32_e64 v34, 16, v111
    v_mfma_f32_16x16x32_bf16 a[240:243], v[196:199], v[148:151], a[240:243]
    buffer_load_dwordx4 v248, s[12:15], s75 offen offset:2048 lds
    ds_read_b64_tr_b16 a[76:77], v253 offset:8
    ds_read_b64_tr_b16 a[78:79], v253 offset:2056
    v_and_b32 v35, 0xffff0000, v111
    s_lshl_b32 s71, s79, 9
    s_mul_i32 s31, s28, 156
    s_add_u32 s71, s71, s31
    s_add_u32 s71, s71, 0xb01000
    v_min_u32 v14, 6, v1
    v_lshlrev_b32 v14, 2, v14
    buffer_load_dword v15, v14, s[16:19], s71 offen sc1
    s_waitcnt lgkmcnt(13)
    v_mfma_f32_16x16x32_bf16 a[236:239], v[200:203], v[140:143], a[236:239]
    ds_read_b128 v[168:171], v9 offset:3648
    v_lshlrev_b32 v16, 16, v119
    v_mfma_f32_16x16x32_bf16 a[240:243], v[200:203], v[144:147], a[240:243]
    ds_read_b64_tr_b16 v[216:217], v8 offset:3720
    v_and_b32 v17, 0xffff0000, v119
    v_mfma_f32_16x16x32_bf16 a[244:247], v[200:203], v[148:151], a[244:247]
    buffer_load_dwordx4 v249, s[12:15], s75 offen offset:3072 lds
    s_add_u32 s75, s75, 32768
    s_cmp_eq_u32 s75, s25
    s_cselect_b32 s27, 458752, 0
    s_sub_u32 s75, s75, s27
    ds_read_b64_tr_b16 v[218:219], v8 offset:3712
    v_add_f32_e64 v34, v34, v16
    v_mfma_f32_16x16x32_bf16 a[236:239], v[188:191], v[152:155], a[236:239]
    s_waitcnt vmcnt(17)
    ds_read_b64_tr_b16 a[80:81], v252 offset:4096
    ds_read_b64_tr_b16 a[82:83], v252 offset:6144
    v_add_f32 v35, v35, v17
    v_mfma_f32_16x16x32_bf16 a[240:243], v[192:195], v[152:155], a[240:243]
    ds_read_b64_tr_b16 a[84:85], v252 offset:4104
    ds_read_b64_tr_b16 a[86:87], v252 offset:6152
    v_lshlrev_b32_e64 v36, 16, v112
    v_mfma_f32_16x16x32_bf16 a[244:247], v[196:199], v[152:155], a[244:247]
    s_waitcnt lgkmcnt(7)
    s_add_u32 m0, s3, 65536
    s_nop 0
    buffer_load_dwordx4 v246, s[12:15], s75 offen offset:0 lds
    ds_read_b64_tr_b16 a[88:89], v253 offset:4096
    ds_read_b64_tr_b16 a[90:91], v253 offset:6144
    v_and_b32 v37, 0xffff0000, v112
    v_mfma_f32_16x16x32_bf16 a[248:251], v[200:203], v[152:155], a[248:251]
    ds_read_b64_tr_b16 a[92:93], v253 offset:4104
    ds_read_b64_tr_b16 a[94:95], v253 offset:6152
    v_lshlrev_b32_e64 v16, 16, v120
    v_mfma_f32_16x16x32_bf16 a[240:243], v[204:207], v[140:143], a[240:243]
    ds_read_b128 v[124:127], v9 offset:0
    v_and_b32 v17, 0xffff0000, v120
    v_mfma_f32_16x16x32_bf16 a[244:247], v[204:207], v[144:147], a[244:247]
    buffer_load_dwordx4 v247, s[12:15], s75 offen offset:1024 lds
    ds_read_b64_tr_b16 v[172:173], v8 offset:200
    v_add_f32_e64 v36, v36, v16
    v_mfma_f32_16x16x32_bf16 a[248:251], v[204:207], v[148:151], a[248:251]
    ds_read_b64_tr_b16 v[174:175], v8 offset:192
    v_add_f32_e64 v37, v37, v17
    v_mfma_f32_16x16x32_bf16 a[252:255], v[204:207], v[152:155], a[252:255]
    s_waitcnt vmcnt(15)
    ds_read_b64_tr_b16 a[96:97], v250 offset:0
    ds_read_b64_tr_b16 a[98:99], v250 offset:2048
    v_lshlrev_b32 v38, 16, v113
    v_mfma_f32_16x16x32_bf16 a[240:243], v[188:191], v[156:159], a[240:243]
    buffer_load_dwordx4 v248, s[12:15], s75 offen offset:2048 lds
    ds_read_b64_tr_b16 a[100:101], v250 offset:8
    ds_read_b64_tr_b16 a[102:103], v250 offset:2056
    v_and_b32 v39, 0xffff0000, v113
    v_mfma_f32_16x16x32_bf16 a[244:247], v[192:195], v[156:159], a[244:247]
    ds_read_b64_tr_b16 a[104:105], v251 offset:0
    ds_read_b64_tr_b16 a[106:107], v251 offset:2048
    v_lshlrev_b32_e64 v16, 16, v121
    v_mfma_f32_16x16x32_bf16 a[248:251], v[196:199], v[156:159], a[248:251]
    ds_read_b64_tr_b16 a[108:109], v251 offset:8
    ds_read_b64_tr_b16 a[110:111], v251 offset:2056
    v_and_b32 v17, 0xffff0000, v121
    v_mfma_f32_16x16x32_bf16 a[252:255], v[200:203], v[156:159], a[252:255]
    buffer_load_dwordx4 v249, s[12:15], s75 offen offset:3072 lds
    s_add_u32 s75, s75, 32768
    s_cmp_eq_u32 s75, s25
    s_cselect_b32 s27, 458752, 0
    s_sub_u32 s75, s75, s27
    v_add_f32_e64 v38, v38, v16
    v_mfma_f32_16x16x32_bf16 a[244:247], v[208:211], v[140:143], a[244:247]
    ds_read_b128 v[128:131], v9 offset:512
    v_add_f32_e64 v39, v39, v17
    v_mfma_f32_16x16x32_bf16 a[248:251], v[208:211], v[144:147], a[248:251]
    ds_read_b64_tr_b16 v[176:177], v8 offset:712
    v_lshlrev_b32_e64 v40, 16, v114
    v_mfma_f32_16x16x32_bf16 a[252:255], v[208:211], v[148:151], a[252:255]
    s_waitcnt lgkmcnt(13)
    s_add_u32 m0, s3, 69632
    s_nop 0
    buffer_load_dwordx4 v246, s[12:15], s75 offen offset:0 lds
    ds_read_b64_tr_b16 v[178:179], v8 offset:704
    v_and_b32 v41, 0xffff0000, v114
    v_mfma_f32_16x16x32_bf16 a[244:247], v[188:191], v[160:163], a[244:247]
    v_lshlrev_b32_e64 v16, 16, v122
    v_mfma_f32_16x16x32_bf16 a[248:251], v[192:195], v[160:163], a[248:251]
    v_and_b32 v17, 0xffff0000, v122
    v_mfma_f32_16x16x32_bf16 a[252:255], v[196:199], v[160:163], a[252:255]
    buffer_load_dwordx4 v247, s[12:15], s75 offen offset:1024 lds
    s_waitcnt vmcnt(15)
    ds_read_b64_tr_b16 a[112:113], v250 offset:4096
    ds_read_b64_tr_b16 a[114:115], v250 offset:6144
    v_add_f32 v40, v40, v16
    v_mfma_f32_16x16x32_bf16 a[248:251], v[212:215], v[140:143], a[248:251]
    ds_read_b128 v[132:135], v9 offset:1024
    v_add_f32_e64 v41, v41, v17
    v_mfma_f32_16x16x32_bf16 a[252:255], v[212:215], v[144:147], a[252:255]
    ds_read_b64_tr_b16 v[180:181], v8 offset:1224
    v_lshlrev_b32_e64 v42, 16, v115
    v_mfma_f32_16x16x32_bf16 a[248:251], v[188:191], v[164:167], a[248:251]
    buffer_load_dwordx4 v248, s[12:15], s75 offen offset:2048 lds
    ds_read_b64_tr_b16 v[182:183], v8 offset:1216
    v_and_b32 v43, 0xffff0000, v115
    v_mfma_f32_16x16x32_bf16 a[252:255], v[192:195], v[164:167], a[252:255]
    ds_read_b64_tr_b16 a[116:117], v250 offset:4104
    ds_read_b64_tr_b16 a[118:119], v250 offset:6152
    v_lshlrev_b32 v16, 16, v123
    s_waitcnt vmcnt(8)
    v_cmp_ne_u32_e64 vcc, s54, v15
    s_mov_b32 s81, 0x10000
    s_cbranch_vccz OK_8
POLL_7:
    s_sub_u32 s81, s81, 1
    s_cbranch_scc1 OK_8
    s_sleep 4
    buffer_load_dword v15, v14, s[16:19], s71 offen sc1
    s_waitcnt vmcnt(0)
    v_cmp_ne_u32 vcc, s54, v15
    s_nop 1
    s_cbranch_vccnz POLL_7
OK_8:
    v_and_b32 v17, 0xffff0000, v123
    v_add_f32 v42, v42, v16
    v_add_f32 v43, v43, v17
    v_mfma_f32_16x16x32_bf16 a[252:255], v[216:219], v[140:143], a[252:255]
    ds_read_b128 v[136:139], v9 offset:1536
    v_mfma_f32_16x16x32_bf16 a[252:255], v[188:191], v[168:171], a[252:255]
    buffer_load_dwordx4 v249, s[12:15], s75 offen offset:3072 lds
    s_add_u32 s75, s75, 32768
    s_cmp_eq_u32 s75, s25
    s_cselect_b32 s27, 458752, 0
    s_sub_u32 s75, s75, s27
    ds_read_b64_tr_b16 v[184:185], v8 offset:1736
    ds_read_b64_tr_b16 v[186:187], v8 offset:1728
    s_waitcnt lgkmcnt(15)
    v_mfma_f32_16x16x32_bf16 a[224:227], v[172:175], v[124:127], a[224:227]
    ds_read_b128 v[140:143], v9 offset:2048
    ds_read_b64_tr_b16 v[188:189], v8 offset:2248
    ds_read_b64_tr_b16 v[190:191], v8 offset:2240
    s_waitcnt lgkmcnt(13)
    v_mfma_f32_16x16x32_bf16 a[228:231], v[176:179], v[124:127], a[228:231]
    ds_read_b128 v[144:147], v9 offset:2560
    v_mfma_f32_16x16x32_bf16 a[228:231], v[172:175], v[128:131], a[228:231]
    s_add_u32 m0, s3, 0
    s_nop 0
    buffer_load_dwordx4 v246, s[12:15], s75 offen offset:0 lds
    ds_read_b64_tr_b16 v[192:193], v8 offset:2760
    v_mfma_f32_16x16x32_bf16 a[232:235], v[176:179], v[128:131], a[232:235]
    ds_read_b64_tr_b16 v[194:195], v8 offset:2752
    s_waitcnt lgkmcnt(11)
    v_mfma_f32_16x16x32_bf16 a[232:235], v[180:183], v[124:127], a[232:235]
    ds_read_b128 v[148:151], v9 offset:3072
    v_mfma_f32_16x16x32_bf16 a[236:239], v[180:183], v[128:131], a[236:239]
    buffer_load_dwordx4 v247, s[12:15], s75 offen offset:1024 lds
    ds_read_b64_tr_b16 v[196:197], v8 offset:3272
    v_mfma_f32_16x16x32_bf16 a[232:235], v[172:175], v[132:135], a[232:235]
    ds_read_b64_tr_b16 v[198:199], v8 offset:3264
    v_mfma_f32_16x16x32_bf16 a[236:239], v[176:179], v[132:135], a[236:239]
    ds_read_b64_tr_b16 a[120:121], v251 offset:4096
    ds_read_b64_tr_b16 a[122:123], v251 offset:6144
    v_mfma_f32_16x16x32_bf16 a[240:243], v[180:183], v[132:135], a[240:243]
    buffer_load_dwordx4 v248, s[12:15], s75 offen offset:2048 lds
    ds_read_b64_tr_b16 a[124:125], v251 offset:4104
    ds_read_b64_tr_b16 a[126:127], v251 offset:6152
    s_waitcnt lgkmcnt(13)
    v_mfma_f32_16x16x32_bf16 a[236:239], v[184:187], v[124:127], a[236:239]
    ds_read_b128 v[152:155], v9 offset:3584
    v_mfma_f32_16x16x32_bf16 a[240:243], v[184:187], v[128:131], a[240:243]
    ds_read_b64_tr_b16 v[200:201], v8 offset:3784
    v_mfma_f32_16x16x32_bf16 a[244:247], v[184:187], v[132:135], a[244:247]
    buffer_load_dwordx4 v249, s[12:15], s75 offen offset:3072 lds
    s_add_u32 s75, s75, 32768
    s_cmp_eq_u32 s75, s25
    s_cselect_b32 s27, 458752, 0
    s_sub_u32 s75, s75, s27
    ds_read_b64_tr_b16 v[202:203], v8 offset:3776
    v_mfma_f32_16x16x32_bf16 a[236:239], v[172:175], v[136:139], a[236:239]
    ds_read_b64_tr_b16 a[128:129], v250 offset:32768
    ds_read_b64_tr_b16 a[130:131], v250 offset:34816
    v_mfma_f32_16x16x32_bf16 a[240:243], v[176:179], v[136:139], a[240:243]
    ds_read_b64_tr_b16 a[132:133], v250 offset:32776
    ds_read_b64_tr_b16 a[134:135], v250 offset:34824
    v_mfma_f32_16x16x32_bf16 a[244:247], v[180:183], v[136:139], a[244:247]
    s_waitcnt lgkmcnt(7)
    s_add_u32 m0, s3, 4096
    s_nop 0
    buffer_load_dwordx4 v246, s[12:15], s75 offen offset:0 lds
    ds_read_b64_tr_b16 a[136:137], v251 offset:32768
    ds_read_b64_tr_b16 a[138:139], v251 offset:34816
    v_mfma_f32_16x16x32_bf16 a[248:251], v[184:187], v[136:139], a[248:251]
    ds_read_b64_tr_b16 a[140:141], v251 offset:32776
    ds_read_b64_tr_b16 a[142:143], v251 offset:34824
    v_mfma_f32_16x16x32_bf16 a[240:243], v[188:191], v[124:127], a[240:243]
    v_mfma_f32_16x16x32_bf16 a[244:247], v[188:191], v[128:131], a[244:247]
    buffer_load_dwordx4 v247, s[12:15], s75 offen offset:1024 lds
    s_waitcnt vmcnt(14)
    ds_read_b64_tr_b16 a[144:145], v250 offset:36864
    ds_read_b64_tr_b16 a[146:147], v250 offset:38912
    v_mfma_f32_16x16x32_bf16 a[248:251], v[188:191], v[132:135], a[248:251]
    ds_read_b64_tr_b16 a[148:149], v250 offset:36872
    ds_read_b64_tr_b16 a[150:151], v250 offset:38920
    v_mfma_f32_16x16x32_bf16 a[252:255], v[188:191], v[136:139], a[252:255]
    ds_read_b64_tr_b16 a[152:153], v251 offset:36864
    ds_read_b64_tr_b16 a[154:155], v251 offset:38912
    v_mfma_f32_16x16x32_bf16 a[240:243], v[172:175], v[140:143], a[240:243]
    buffer_load_dwordx4 v248, s[12:15], s75 offen offset:2048 lds
    ds_read_b64_tr_b16 a[156:157], v251 offset:36872
    ds_read_b64_tr_b16 a[158:159], v251 offset:38920
    v_mfma_f32_16x16x32_bf16 a[244:247], v[176:179], v[140:143], a[244:247]
    v_mfma_f32_16x16x32_bf16 a[248:251], v[180:183], v[140:143], a[248:251]
    v_mfma_f32_16x16x32_bf16 a[252:255], v[184:187], v[140:143], a[252:255]
    buffer_load_dwordx4 v249, s[12:15], s75 offen offset:3072 lds
    s_add_u32 s75, s75, 32768
    s_cmp_eq_u32 s75, s25
    s_cselect_b32 s27, 458752, 0
    s_sub_u32 s75, s75, s27
    v_mfma_f32_16x16x32_bf16 a[244:247], v[192:195], v[124:127], a[244:247]
    v_mfma_f32_16x16x32_bf16 a[248:251], v[192:195], v[128:131], a[248:251]
    v_mfma_f32_16x16x32_bf16 a[252:255], v[192:195], v[132:135], a[252:255]
    buffer_load_dwordx4 v[44:47], v13, s[16:19], s72 offen sc1
    v_mfma_f32_16x16x32_bf16 a[244:247], v[172:175], v[144:147], a[244:247]
    v_mfma_f32_16x16x32_bf16 a[248:251], v[176:179], v[144:147], a[248:251]
    v_mfma_f32_16x16x32_bf16 a[252:255], v[180:183], v[144:147], a[252:255]
    buffer_load_dwordx4 v[48:51], v13, s[16:19], s73 offen sc1
    s_add_u32 s26, s26, 1024
    s_cmp_eq_u32 s26, 14336
    s_cselect_b32 s26, 0, s26
    v_mfma_f32_16x16x32_bf16 a[248:251], v[196:199], v[124:127], a[248:251]
    v_mfma_f32_16x16x32_bf16 a[252:255], v[196:199], v[128:131], a[252:255]
    v_mfma_f32_16x16x32_bf16 a[248:251], v[172:175], v[148:151], a[248:251]
    buffer_load_dwordx4 v[52:55], v13, s[16:19], s76 offen sc1
    v_mfma_f32_16x16x32_bf16 a[252:255], v[176:179], v[148:151], a[252:255]
    s_waitcnt lgkmcnt(15)
    v_mfma_f32_16x16x32_bf16 a[252:255], v[200:203], v[124:127], a[252:255]
    v_mfma_f32_16x16x32_bf16 a[252:255], v[172:175], v[152:155], a[252:255]
    buffer_load_dwordx4 v[56:59], v13, s[16:19], s77 offen sc1
    v_add_u32_e64 v13, s26, v6
    s_lshl_b32 s31, s28, 13
    s_add_u32 s31, s31, 32768
    v_bfe_u32 v9, v0, 1, 2
    v_xor_b32 v9, v9, v3
    v_lshlrev_b32 v9, 4, v9
    v_lshl_add_u32 v9, v2, 6, v9
    v_add_u32_e64 v9, s31, v9
    ds_write_b128 v9, a[224:227] offset:0
    buffer_load_dwordx4 v[60:63], v13, s[16:19], s72 offen sc1
    ds_write_b128 v9, a[228:231] offset:1024
    buffer_load_dwordx4 v[64:67], v13, s[16:19], s73 offen sc1
    s_add_u32 s26, s26, 1024
    s_cmp_eq_u32 s26, 14336
    s_cselect_b32 s26, 0, s26
    ds_write_b128 v9, a[232:235] offset:2048
    buffer_load_dwordx4 v[68:71], v13, s[16:19], s76 offen sc1
    ds_write_b128 v9, a[236:239] offset:3072
    buffer_load_dwordx4 v[72:75], v13, s[16:19], s77 offen sc1
    v_add_u32 v13, s26, v6
    ds_write_b128 v9, a[240:243] offset:4096
    buffer_load_dwordx4 v[76:79], v13, s[16:19], s72 offen sc1
    ds_write_b128 v9, a[244:247] offset:5120
    buffer_load_dwordx4 v[80:83], v13, s[16:19], s73 offen sc1
    s_add_u32 s26, s26, 1024
    s_cmp_eq_u32 s26, 14336
    s_cselect_b32 s26, 0, s26
    ds_write_b128 v9, a[248:251] offset:6144
    buffer_load_dwordx4 v[84:87], v13, s[16:19], s76 offen sc1
    ds_write_b128 v9, a[252:255] offset:7168
    buffer_load_dwordx4 v[88:91], v13, s[16:19], s77 offen sc1
    v_add_u32_e64 v13, s26, v6
    s_and_b32 s31, s28, 2
    s_lshl_b32 s31, s31, 13
    s_and_b32 s32, s28, 1
    s_lshl_b32 s32, s32, 12
    s_add_u32 s31, s31, s32
    s_add_u32 s31, s31, 32768
    v_lshlrev_b32 v8, 1, v1
    v_xor_b32 v8, v8, v4
    v_lshlrev_b32 v8, 4, v8
    v_add_u32 v8, s31, v8
    v_xor_b32 v10, 16, v8
    s_lshl_b32 s31, s78, 13
    s_lshl_b32 s32, s28, 11
    s_add_u32 s31, s31, s32
    s_add_u32 s31, s31, 0x900000
    s_waitcnt lgkmcnt(0)
    s_barrier
    ds_read_b128 v[172:175], v8 offset:0
    ds_read_b128 v[176:179], v10 offset:0
    ds_read_b128 v[180:183], v8 offset:8192
    ds_read_b128 v[184:187], v10 offset:8192
    ds_read_b128 v[188:191], v8 offset:2048
    ds_read_b128 v[192:195], v10 offset:2048
    ds_read_b128 v[196:199], v8 offset:10240
    ds_read_b128 v[200:203], v10 offset:10240
    s_waitcnt lgkmcnt(4)
    s_nop 0
    v_pk_add_f32 v[172:173], v[172:173], v[180:181]
    v_pk_add_f32 v[174:175], v[174:175], v[182:183]
    v_pk_add_f32 v[176:177], v[176:177], v[184:185]
    v_pk_add_f32 v[178:179], v[178:179], v[186:187]
    v_cvt_pk_bf16_f32 v228, v172, v173
    v_cvt_pk_bf16_f32 v229, v174, v175
    v_cvt_pk_bf16_f32 v230, v176, v177
    v_cvt_pk_bf16_f32 v231, v178, v179
    buffer_store_dwordx4 v[228:231], v6, s[16:19], s31 offen offset:0 sc1
    s_waitcnt lgkmcnt(0)
    s_nop 0
    v_pk_add_f32 v[188:189], v[188:189], v[196:197]
    v_pk_add_f32 v[190:191], v[190:191], v[198:199]
    v_pk_add_f32 v[192:193], v[192:193], v[200:201]
    v_pk_add_f32 v[194:195], v[194:195], v[202:203]
    v_cvt_pk_bf16_f32 v232, v188, v189
    v_cvt_pk_bf16_f32 v233, v190, v191
    v_cvt_pk_bf16_f32 v234, v192, v193
    v_cvt_pk_bf16_f32 v235, v194, v195
    buffer_store_dwordx4 v[232:235], v6, s[16:19], s31 offen offset:1024 sc1
    buffer_load_dwordx4 v[92:95], v13, s[16:19], s72 offen sc1
    buffer_load_dwordx4 v[96:99], v13, s[16:19], s73 offen sc1
    s_add_u32 s26, s26, 1024
    s_cmp_eq_u32 s26, 14336
    s_cselect_b32 s26, 0, s26
    buffer_load_dwordx4 v[100:103], v13, s[16:19], s76 offen sc1
    buffer_load_dwordx4 v[104:107], v13, s[16:19], s77 offen sc1
    v_add_u32 v13, s26, v6
    buffer_load_dwordx4 v[108:111], v13, s[16:19], s72 offen sc1
    buffer_load_dwordx4 v[112:115], v13, s[16:19], s73 offen sc1
    s_add_u32 s26, s26, 1024
    s_cmp_eq_u32 s26, 14336
    s_cselect_b32 s26, 0, s26
    buffer_load_dwordx4 v[116:119], v13, s[16:19], s76 offen sc1
    buffer_load_dwordx4 v[120:123], v13, s[16:19], s77 offen sc1
    v_add_u32_e64 v13, s26, v6
    s_waitcnt vmcnt(21)
    v_mfma_f32_16x16x32_bf16 v[28:31], a[0:3], v[44:47], v[28:31]
    ds_read_b64_tr_b16 a[160:161], v252 offset:0
    ds_read_b64_tr_b16 a[162:163], v252 offset:2048
    v_mfma_f32_16x16x32_bf16 v[32:35], a[4:7], v[44:47], v[32:35]
    v_mfma_f32_16x16x32_bf16 v[36:39], a[8:11], v[44:47], v[36:39]
    ds_read_b64_tr_b16 a[164:165], v252 offset:8
    ds_read_b64_tr_b16 a[166:167], v252 offset:2056
    v_mfma_f32_16x16x32_bf16 v[40:43], a[12:15], v[44:47], v[40:43]
    buffer_load_dwordx4 v[124:127], v13, s[16:19], s72 offen sc1
    s_waitcnt vmcnt(21)
    v_mfma_f32_16x16x32_bf16 v[172:175], a[0:3], v[48:51], 0
    ds_read_b64_tr_b16 a[168:169], v253 offset:0
    ds_read_b64_tr_b16 a[170:171], v253 offset:2048
    v_mfma_f32_16x16x32_bf16 v[176:179], a[4:7], v[48:51], 0
    v_mfma_f32_16x16x32_bf16 v[180:183], a[8:11], v[48:51], 0
    ds_read_b64_tr_b16 a[172:173], v253 offset:8
    ds_read_b64_tr_b16 a[174:175], v253 offset:2056
    v_mfma_f32_16x16x32_bf16 v[184:187], a[12:15], v[48:51], 0
    buffer_load_dwordx4 v[128:131], v13, s[16:19], s73 offen sc1
    s_add_u32 s26, s26, 1024
    s_cmp_eq_u32 s26, 14336
    s_cselect_b32 s26, 0, s26
    s_waitcnt vmcnt(21)
    v_mfma_f32_16x16x32_bf16 v[188:191], a[0:3], v[52:55], 0
    ds_read_b64_tr_b16 a[176:177], v252 offset:4096
    ds_read_b64_tr_b16 a[178:179], v252 offset:6144
    v_mfma_f32_16x16x32_bf16 v[192:195], a[4:7], v[52:55], 0
    v_mfma_f32_16x16x32_bf16 v[196:199], a[8:11], v[52:55], 0
    ds_read_b64_tr_b16 a[180:181], v252 offset:4104
    ds_read_b64_tr_b16 a[182:183], v252 offset:6152
    v_mfma_f32_16x16x32_bf16 v[200:203], a[12:15], v[52:55], 0
    buffer_load_dwordx4 v[132:135], v13, s[16:19], s76 offen sc1
    s_waitcnt vmcnt(21)
    v_mfma_f32_16x16x32_bf16 v[204:207], a[0:3], v[56:59], 0
    ds_read_b64_tr_b16 a[184:185], v253 offset:4096
    ds_read_b64_tr_b16 a[186:187], v253 offset:6144
    v_mfma_f32_16x16x32_bf16 v[208:211], a[4:7], v[56:59], 0
    v_mfma_f32_16x16x32_bf16 v[212:215], a[8:11], v[56:59], 0
    ds_read_b64_tr_b16 a[188:189], v253 offset:4104
    ds_read_b64_tr_b16 a[190:191], v253 offset:6152
    v_mfma_f32_16x16x32_bf16 v[216:219], a[12:15], v[56:59], 0
    buffer_load_dwordx4 v[136:139], v13, s[16:19], s77 offen sc1
    v_add_u32 v13, s26, v6
    s_waitcnt vmcnt(21)
    v_mfma_f32_16x16x32_bf16 v[28:31], a[16:19], v[60:63], v[28:31]
    ds_read_b64_tr_b16 a[192:193], v250 offset:0
    ds_read_b64_tr_b16 a[194:195], v250 offset:2048
    v_mfma_f32_16x16x32_bf16 v[32:35], a[20:23], v[60:63], v[32:35]
    v_mfma_f32_16x16x32_bf16 v[36:39], a[24:27], v[60:63], v[36:39]
    ds_read_b64_tr_b16 a[196:197], v250 offset:8
    ds_read_b64_tr_b16 a[198:199], v250 offset:2056
    v_mfma_f32_16x16x32_bf16 v[40:43], a[28:31], v[60:63], v[40:43]
    buffer_load_dwordx4 v[140:143], v13, s[16:19], s72 offen sc1
    s_waitcnt vmcnt(21)
    v_mfma_f32_16x16x32_bf16 v[172:175], a[16:19], v[64:67], v[172:175]
    ds_read_b64_tr_b16 a[200:201], v251 offset:0
    ds_read_b64_tr_b16 a[202:203], v251 offset:2048
    v_mfma_f32_16x16x32_bf16 v[176:179], a[20:23], v[64:67], v[176:179]
    v_mfma_f32_16x16x32_bf16 v[180:183], a[24:27], v[64:67], v[180:183]
    ds_read_b64_tr_b16 a[204:205], v251 offset:8
    ds_read_b64_tr_b16 a[206:207], v251 offset:2056
    v_mfma_f32_16x16x32_bf16 v[184:187], a[28:31], v[64:67], v[184:187]
    buffer_load_dwordx4 v[144:147], v13, s[16:19], s73 offen sc1
    s_add_u32 s26, s26, 1024
    s_cmp_eq_u32 s26, 14336
    s_cselect_b32 s26, 0, s26
    s_waitcnt vmcnt(21)
    v_mfma_f32_16x16x32_bf16 v[188:191], a[16:19], v[68:71], v[188:191]
    ds_read_b64_tr_b16 a[208:209], v250 offset:4096
    ds_read_b64_tr_b16 a[210:211], v250 offset:6144
    v_mfma_f32_16x16x32_bf16 v[192:195], a[20:23], v[68:71], v[192:195]
    v_mfma_f32_16x16x32_bf16 v[196:199], a[24:27], v[68:71], v[196:199]
    ds_read_b64_tr_b16 a[212:213], v250 offset:4104
    ds_read_b64_tr_b16 a[214:215], v250 offset:6152
    v_mfma_f32_16x16x32_bf16 v[200:203], a[28:31], v[68:71], v[200:203]
    buffer_load_dwordx4 v[148:151], v13, s[16:19], s76 offen sc1
    s_waitcnt vmcnt(21)
    v_mfma_f32_16x16x32_bf16 v[204:207], a[16:19], v[72:75], v[204:207]
    ds_read_b64_tr_b16 a[216:217], v251 offset:4096
    ds_read_b64_tr_b16 a[218:219], v251 offset:6144
    v_mfma_f32_16x16x32_bf16 v[208:211], a[20:23], v[72:75], v[208:211]
    v_mfma_f32_16x16x32_bf16 v[212:215], a[24:27], v[72:75], v[212:215]
    ds_read_b64_tr_b16 a[220:221], v251 offset:4104
    ds_read_b64_tr_b16 a[222:223], v251 offset:6152
    v_mfma_f32_16x16x32_bf16 v[216:219], a[28:31], v[72:75], v[216:219]
    buffer_load_dwordx4 v[152:155], v13, s[16:19], s77 offen sc1
    v_add_u32_e64 v13, s26, v6
    s_lshl_b32 s31, s29, 11
    s_and_b32 s32, s28, 1
    s_lshl_b32 s32, s32, 10
    s_add_u32 s31, s31, s32
    s_lshl_b32 s32, s80, 7
    s_add_u32 s31, s31, s32
    s_and_b32 s32, s30, 3
    s_lshl_b32 s32, s32, 3
    s_and_b32 s33, s28, 2
    s_lshl_b32 s33, s33, 1
    s_add_u32 s31, s31, s32
    s_add_u32 s31, s31, s33
    s_add_u32 s31, s31, 0xb05000
    s_waitcnt vmcnt(16)
    v_lshlrev_b32 v22, 26, v1
    v_mov_b32_e64 v23, s54
    buffer_store_dword v23, v22, s[16:19], s31 offen sc1
    v_mfma_f32_16x16x32_bf16 v[28:31], a[32:35], v[76:79], v[28:31]
    s_lshl_b32 s71, s80, 11
    v_mfma_f32_16x16x32_bf16 v[32:35], a[36:39], v[76:79], v[32:35]
    s_lshr_b32 s31, s79, 4
    v_mfma_f32_16x16x32_bf16 v[36:39], a[40:43], v[76:79], v[36:39]
    v_mfma_f32_16x16x32_bf16 v[40:43], a[44:47], v[76:79], v[40:43]
    buffer_load_dwordx4 v[156:159], v13, s[16:19], s72 offen sc1
    s_lshl_b32 s31, s31, 10
    v_mfma_f32_16x16x32_bf16 v[172:175], a[32:35], v[80:83], v[172:175]
    s_add_u32 s71, s71, s31
    v_mfma_f32_16x16x32_bf16 v[176:179], a[36:39], v[80:83], v[176:179]
    s_add_u32 s71, s71, 0xb05000
    v_mfma_f32_16x16x32_bf16 v[180:183], a[40:43], v[80:83], v[180:183]
    v_mfma_f32_16x16x32_bf16 v[184:187], a[44:47], v[80:83], v[184:187]
    buffer_load_dwordx4 v[160:163], v13, s[16:19], s73 offen sc1
    s_add_u32 s26, s26, 1024
    s_cmp_eq_u32 s26, 14336
    s_cselect_b32 s26, 0, s26
    s_lshl_b32 s31, s28, 8
    v_mfma_f32_16x16x32_bf16 v[188:191], a[32:35], v[84:87], v[188:191]
    s_add_u32 s71, s71, s31
    v_mfma_f32_16x16x32_bf16 v[192:195], a[36:39], v[84:87], v[192:195]
    v_and_b32 v14, 7, v0
    v_mfma_f32_16x16x32_bf16 v[196:199], a[40:43], v[84:87], v[196:199]
    v_mfma_f32_16x16x32_bf16 v[200:203], a[44:47], v[84:87], v[200:203]
    buffer_load_dwordx4 v[164:167], v13, s[16:19], s76 offen sc1
    v_and_b32_e64 v15, 8, v0
    v_mfma_f32_16x16x32_bf16 v[204:207], a[32:35], v[88:91], v[204:207]
    v_lshlrev_b32_e64 v14, 2, v14
    v_mfma_f32_16x16x32_bf16 v[208:211], a[36:39], v[88:91], v[208:211]
    v_lshl_add_u32 v14, v15, 4, v14
    v_mfma_f32_16x16x32_bf16 v[212:215], a[40:43], v[88:91], v[212:215]
    v_mfma_f32_16x16x32_bf16 v[216:219], a[44:47], v[88:91], v[216:219]
    buffer_load_dwordx4 v[168:171], v13, s[16:19], s77 offen sc1
    v_add_u32_e64 v13, s26, v6
    s_and_b32 s31, s28, 1
    s_waitcnt vmcnt(20)
    v_mfma_f32_16x16x32_bf16 v[28:31], a[48:51], v[92:95], v[28:31]
    s_lshl_b32 s31, s31, 2
    v_mfma_f32_16x16x32_bf16 v[32:35], a[52:55], v[92:95], v[32:35]
    v_and_b32 v21, 1, v3
    v_mfma_f32_16x16x32_bf16 v[36:39], a[56:59], v[92:95], v[36:39]
    v_mfma_f32_16x16x32_bf16 v[40:43], a[60:63], v[92:95], v[40:43]
    buffer_load_dwordx4 v[44:47], v13, s[16:19], s72 offen sc1
    v_and_b32 v10, 7, v0
    s_waitcnt vmcnt(20)
    v_mfma_f32_16x16x32_bf16 v[172:175], a[48:51], v[96:99], v[172:175]
    v_xor_b32_e64 v10, v10, v21
    v_mfma_f32_16x16x32_bf16 v[176:179], a[52:55], v[96:99], v[176:179]
    v_xor_b32_e64 v10, s31, v10
    v_mfma_f32_16x16x32_bf16 v[180:183], a[56:59], v[96:99], v[180:183]
    v_mfma_f32_16x16x32_bf16 v[184:187], a[60:63], v[96:99], v[184:187]
    buffer_load_dwordx4 v[48:51], v13, s[16:19], s73 offen sc1
    s_add_u32 s26, s26, 1024
    s_cmp_eq_u32 s26, 14336
    s_cselect_b32 s26, 0, s26
    v_lshrrev_b32_e64 v21, 3, v1
    s_waitcnt vmcnt(20)
    v_mfma_f32_16x16x32_bf16 v[188:191], a[48:51], v[100:103], v[188:191]
    v_lshlrev_b32_e64 v21, 12, v21
    v_mfma_f32_16x16x32_bf16 v[192:195], a[52:55], v[100:103], v[192:195]
    v_lshl_add_u32 v10, v10, 4, v21
    v_mfma_f32_16x16x32_bf16 v[196:199], a[56:59], v[100:103], v[196:199]
    v_mfma_f32_16x16x32_bf16 v[200:203], a[60:63], v[100:103], v[200:203]
    buffer_load_dwordx4 v[52:55], v13, s[16:19], s76 offen sc1
    v_xor_b32 v21, 32, v10
    s_waitcnt vmcnt(20)
    v_mfma_f32_16x16x32_bf16 v[204:207], a[48:51], v[104:107], v[204:207]
    v_add_u32 v21, 31744, v21
    v_mfma_f32_16x16x32_bf16 v[208:211], a[52:55], v[104:107], v[208:211]
    s_lshl_b32 s31, s80, 18
    v_mfma_f32_16x16x32_bf16 v[212:215], a[56:59], v[104:107], v[212:215]
    v_mfma_f32_16x16x32_bf16 v[216:219], a[60:63], v[104:107], v[216:219]
    buffer_load_dwordx4 v[56:59], v13, s[16:19], s77 offen sc1
    v_add_u32 v13, s26, v6
    s_lshl_b32 s32, s79, 7
    s_waitcnt vmcnt(20)
    v_mfma_f32_16x16x32_bf16 v[28:31], a[64:67], v[108:111], v[28:31]
    s_add_u32 s31, s31, s32
    v_mfma_f32_16x16x32_bf16 v[32:35], a[68:71], v[108:111], v[32:35]
    s_lshl_b32 s32, s28, 16
    v_mfma_f32_16x16x32_bf16 v[36:39], a[72:75], v[108:111], v[36:39]
    v_mfma_f32_16x16x32_bf16 v[40:43], a[76:79], v[108:111], v[40:43]
    buffer_load_dwordx4 v[60:63], v13, s[16:19], s72 offen sc1
    s_add_u32 s31, s31, s32
    s_waitcnt vmcnt(20)
    v_mfma_f32_16x16x32_bf16 v[172:175], a[64:67], v[112:115], v[172:175]
    s_add_u32 s70, s31, 0x900000
    v_mfma_f32_16x16x32_bf16 v[176:179], a[68:71], v[112:115], v[176:179]
    s_lshl_b32 s31, s28, 1
    v_mfma_f32_16x16x32_bf16 v[180:183], a[72:75], v[112:115], v[180:183]
    v_mfma_f32_16x16x32_bf16 v[184:187], a[76:79], v[112:115], v[184:187]
    buffer_load_dwordx4 v[64:67], v13, s[16:19], s73 offen sc1
    s_add_u32 s26, s26, 1024
    s_cmp_eq_u32 s26, 14336
    s_cselect_b32 s26, 0, s26
    v_lshrrev_b32 v8, 1, v2
    s_waitcnt vmcnt(20)
    v_mfma_f32_16x16x32_bf16 v[188:191], a[64:67], v[116:119], v[188:191]
    v_xor_b32_e64 v8, s31, v8
    v_mfma_f32_16x16x32_bf16 v[192:195], a[68:71], v[116:119], v[192:195]
    v_lshrrev_b32_e64 v9, 1, v3
    v_mfma_f32_16x16x32_bf16 v[196:199], a[72:75], v[116:119], v[196:199]
    v_mfma_f32_16x16x32_bf16 v[200:203], a[76:79], v[116:119], v[200:203]
    buffer_load_dwordx4 v[68:71], v13, s[16:19], s76 offen sc1
    v_xor_b32 v8, v8, v9
    s_waitcnt vmcnt(20)
    v_mfma_f32_16x16x32_bf16 v[204:207], a[64:67], v[120:123], v[204:207]
    v_and_b32_e64 v9, 1, v3
    v_mfma_f32_16x16x32_bf16 v[208:211], a[68:71], v[120:123], v[208:211]
    v_lshl_add_u32 v8, v8, 1, v9
    v_mfma_f32_16x16x32_bf16 v[212:215], a[72:75], v[120:123], v[212:215]
    v_mfma_f32_16x16x32_bf16 v[216:219], a[76:79], v[120:123], v[216:219]
    buffer_load_dwordx4 v[72:75], v13, s[16:19], s77 offen sc1
    v_add_u32_e64 v13, s26, v6
    v_lshl_add_u32 v9, v4, 3, v5
    s_waitcnt vmcnt(20)
    v_mfma_f32_16x16x32_bf16 v[28:31], a[80:83], v[124:127], v[28:31]
    v_lshlrev_b32 v9, 7, v9
    v_mfma_f32_16x16x32_bf16 v[32:35], a[84:87], v[124:127], v[32:35]
    v_lshl_add_u32 v8, v8, 3, v9
    v_mfma_f32_16x16x32_bf16 v[36:39], a[88:91], v[124:127], v[36:39]
    v_mfma_f32_16x16x32_bf16 v[40:43], a[92:95], v[124:127], v[40:43]
    buffer_load_dwordx4 v[76:79], v13, s[16:19], s72 offen sc1
    v_add_u32 v8, 147456, v8
    s_waitcnt vmcnt(20)
    v_mfma_f32_16x16x32_bf16 v[172:175], a[80:83], v[128:131], v[172:175]
    v_lshlrev_b32 v9, 2, v3
    v_mfma_f32_16x16x32_bf16 v[176:179], a[84:87], v[128:131], v[176:179]
    v_sub_u32_e64 v9, v2, v9
    v_mfma_f32_16x16x32_bf16 v[180:183], a[88:91], v[128:131], v[180:183]
    v_mfma_f32_16x16x32_bf16 v[184:187], a[92:95], v[128:131], v[184:187]
    buffer_load_dwordx4 v[80:83], v13, s[16:19], s73 offen sc1
    s_add_u32 s26, s26, 1024
    s_cmp_eq_u32 s26, 14336
    s_cselect_b32 s26, 0, s26
    s_nop 0
    v_mov_b32 v16, 0x3f80
    s_waitcnt vmcnt(20)
    v_mfma_f32_16x16x32_bf16 v[188:191], a[80:83], v[132:135], v[188:191]
    v_mov_b32 v17, 0
    v_mfma_f32_16x16x32_bf16 v[192:195], a[84:87], v[132:135], v[192:195]
    v_cmp_gt_u32_e64 vcc, 4, v9
    v_mfma_f32_16x16x32_bf16 v[196:199], a[88:91], v[132:135], v[196:199]
    v_mfma_f32_16x16x32_bf16 v[200:203], a[92:95], v[132:135], v[200:203]
    buffer_load_dwordx4 v[84:87], v13, s[16:19], s76 offen sc1
    v_lshlrev_b32 v9, 4, v9
    s_waitcnt vmcnt(20)
    v_mfma_f32_16x16x32_bf16 v[204:207], a[80:83], v[136:139], v[204:207]
    v_cndmask_b32_e64 v16, 0, v16, vcc
    v_mfma_f32_16x16x32_bf16 v[208:211], a[84:87], v[136:139], v[208:211]
    v_lshlrev_b64 v[16:17], v9, v[16:17]
    v_mfma_f32_16x16x32_bf16 v[212:215], a[88:91], v[136:139], v[212:215]
    v_mfma_f32_16x16x32_bf16 v[216:219], a[92:95], v[136:139], v[216:219]
    buffer_load_dwordx4 v[88:91], v13, s[16:19], s77 offen sc1
    v_add_u32_e64 v13, s26, v6
    s_xor_b32 s31, s28, 1
    s_waitcnt vmcnt(20)
    v_mfma_f32_16x16x32_bf16 v[28:31], a[96:99], v[140:143], v[28:31]
    s_mul_i32 s31, s31, 12288
    v_mfma_f32_16x16x32_bf16 v[32:35], a[100:103], v[140:143], v[32:35]
    s_add_u32 s31, s31, 98304
    v_mfma_f32_16x16x32_bf16 v[36:39], a[104:107], v[140:143], v[36:39]
    v_mfma_f32_16x16x32_bf16 v[40:43], a[108:111], v[140:143], v[40:43]
    buffer_load_dwordx4 v[92:95], v13, s[16:19], s72 offen sc1
    v_add_u32 v18, s31, v6
    s_waitcnt vmcnt(20)
    v_mfma_f32_16x16x32_bf16 v[172:175], a[96:99], v[144:147], v[172:175]
    s_xor_b32 s31, s28, 2
    v_mfma_f32_16x16x32_bf16 v[176:179], a[100:103], v[144:147], v[176:179]
    s_mul_i32 s31, s31, 12288
    v_mfma_f32_16x16x32_bf16 v[180:183], a[104:107], v[144:147], v[180:183]
    v_mfma_f32_16x16x32_bf16 v[184:187], a[108:111], v[144:147], v[184:187]
    buffer_load_dwordx4 v[96:99], v13, s[16:19], s73 offen sc1
    s_add_u32 s26, s26, 1024
    s_cmp_eq_u32 s26, 14336
    s_cselect_b32 s26, 0, s26
    s_add_u32 s31, s31, 102400
    s_waitcnt vmcnt(20)
    v_mfma_f32_16x16x32_bf16 v[188:191], a[96:99], v[148:151], v[188:191]
    v_add_u32 v19, s31, v6
    v_mfma_f32_16x16x32_bf16 v[192:195], a[100:103], v[148:151], v[192:195]
    s_xor_b32 s31, s28, 3
    v_mfma_f32_16x16x32_bf16 v[196:199], a[104:107], v[148:151], v[196:199]
    v_mfma_f32_16x16x32_bf16 v[200:203], a[108:111], v[148:151], v[200:203]
    buffer_load_dwordx4 v[100:103], v13, s[16:19], s76 offen sc1
    s_mul_i32 s31, s31, 12288
    s_waitcnt vmcnt(20)
    v_mfma_f32_16x16x32_bf16 v[204:207], a[96:99], v[152:155], v[204:207]
    s_add_u32 s31, s31, 106496
    v_mfma_f32_16x16x32_bf16 v[208:211], a[100:103], v[152:155], v[208:211]
    v_add_u32_e64 v20, s31, v6
    v_mfma_f32_16x16x32_bf16 v[212:215], a[104:107], v[152:155], v[212:215]
    v_mfma_f32_16x16x32_bf16 v[216:219], a[108:111], v[152:155], v[216:219]
    buffer_load_dwordx4 v[104:107], v13, s[16:19], s77 offen sc1
    v_add_u32_e64 v13, s26, v6
    s_mul_i32 s31, s28, 12288
    s_waitcnt vmcnt(19)
    v_mfma_f32_16x16x32_bf16 v[28:31], a[112:115], v[156:159], v[28:31]
    s_add_u32 s31, s31, 98304
    v_mfma_f32_16x16x32_bf16 v[32:35], a[116:119], v[156:159], v[32:35]
    v_add_u32 v9, s31, v6
    v_mfma_f32_16x16x32_bf16 v[36:39], a[120:123], v[156:159], v[36:39]
    v_mfma_f32_16x16x32_bf16 v[40:43], a[124:127], v[156:159], v[40:43]
    buffer_load_dwordx4 v[108:111], v13, s[16:19], s72 offen sc1
    s_waitcnt vmcnt(19)
    v_mfma_f32_16x16x32_bf16 v[172:175], a[112:115], v[160:163], v[172:175]
    v_mfma_f32_16x16x32_bf16 v[176:179], a[116:119], v[160:163], v[176:179]
    v_mfma_f32_16x16x32_bf16 v[180:183], a[120:123], v[160:163], v[180:183]
    v_mfma_f32_16x16x32_bf16 v[184:187], a[124:127], v[160:163], v[184:187]
    buffer_load_dwordx4 v[112:115], v13, s[16:19], s73 offen sc1
    s_add_u32 s26, s26, 1024
    s_cmp_eq_u32 s26, 14336
    s_cselect_b32 s26, 0, s26
    s_waitcnt vmcnt(19)
    v_mfma_f32_16x16x32_bf16 v[188:191], a[112:115], v[164:167], v[188:191]
    v_mfma_f32_16x16x32_bf16 v[192:195], a[116:119], v[164:167], v[192:195]
    v_mfma_f32_16x16x32_bf16 v[196:199], a[120:123], v[164:167], v[196:199]
    v_mfma_f32_16x16x32_bf16 v[200:203], a[124:127], v[164:167], v[200:203]
    buffer_load_dwordx4 v[116:119], v13, s[16:19], s76 offen sc1
    s_waitcnt vmcnt(19)
    v_mfma_f32_16x16x32_bf16 v[204:207], a[112:115], v[168:171], v[204:207]
    v_mfma_f32_16x16x32_bf16 v[208:211], a[116:119], v[168:171], v[208:211]
    v_mfma_f32_16x16x32_bf16 v[212:215], a[120:123], v[168:171], v[212:215]
    v_mfma_f32_16x16x32_bf16 v[216:219], a[124:127], v[168:171], v[216:219]
    buffer_load_dwordx4 v[120:123], v13, s[16:19], s77 offen sc1
    v_add_u32_e64 v13, s26, v6
    buffer_load_dword v15, v14, s[16:19], s71 offen sc1
    s_waitcnt vmcnt(20)
    v_mfma_f32_16x16x32_bf16 v[28:31], a[128:131], v[44:47], v[28:31]
    v_mfma_f32_16x16x32_bf16 v[32:35], a[132:135], v[44:47], v[32:35]
    v_mfma_f32_16x16x32_bf16 v[36:39], a[136:139], v[44:47], v[36:39]
    v_mfma_f32_16x16x32_bf16 v[40:43], a[140:143], v[44:47], v[40:43]
    buffer_load_dwordx4 v[124:127], v13, s[16:19], s72 offen sc1
    s_waitcnt vmcnt(20)
    v_mfma_f32_16x16x32_bf16 v[172:175], a[128:131], v[48:51], v[172:175]
    v_mfma_f32_16x16x32_bf16 v[176:179], a[132:135], v[48:51], v[176:179]
    v_mfma_f32_16x16x32_bf16 v[180:183], a[136:139], v[48:51], v[180:183]
    v_mfma_f32_16x16x32_bf16 v[184:187], a[140:143], v[48:51], v[184:187]
    buffer_load_dwordx4 v[128:131], v13, s[16:19], s73 offen sc1
    s_add_u32 s26, s26, 1024
    s_cmp_eq_u32 s26, 14336
    s_cselect_b32 s26, 0, s26
    s_waitcnt vmcnt(20)
    v_mfma_f32_16x16x32_bf16 v[188:191], a[128:131], v[52:55], v[188:191]
    v_mfma_f32_16x16x32_bf16 v[192:195], a[132:135], v[52:55], v[192:195]
    v_mfma_f32_16x16x32_bf16 v[196:199], a[136:139], v[52:55], v[196:199]
    v_mfma_f32_16x16x32_bf16 v[200:203], a[140:143], v[52:55], v[200:203]
    buffer_load_dwordx4 v[132:135], v13, s[16:19], s76 offen sc1
    s_waitcnt vmcnt(20)
    v_mfma_f32_16x16x32_bf16 v[204:207], a[128:131], v[56:59], v[204:207]
    v_mfma_f32_16x16x32_bf16 v[208:211], a[132:135], v[56:59], v[208:211]
    v_mfma_f32_16x16x32_bf16 v[212:215], a[136:139], v[56:59], v[212:215]
    v_mfma_f32_16x16x32_bf16 v[216:219], a[140:143], v[56:59], v[216:219]
    buffer_load_dwordx4 v[136:139], v13, s[16:19], s77 offen sc1
    v_add_u32_e64 v13, s26, v6
    s_waitcnt vmcnt(20)
    v_mfma_f32_16x16x32_bf16 v[28:31], a[144:147], v[60:63], v[28:31]
    v_mfma_f32_16x16x32_bf16 v[32:35], a[148:151], v[60:63], v[32:35]
    v_mfma_f32_16x16x32_bf16 v[36:39], a[152:155], v[60:63], v[36:39]
    v_mfma_f32_16x16x32_bf16 v[40:43], a[156:159], v[60:63], v[40:43]
    s_waitcnt vmcnt(19)
    v_mfma_f32_16x16x32_bf16 v[172:175], a[144:147], v[64:67], v[172:175]
    v_mfma_f32_16x16x32_bf16 v[176:179], a[148:151], v[64:67], v[176:179]
    v_mfma_f32_16x16x32_bf16 v[180:183], a[152:155], v[64:67], v[180:183]
    v_mfma_f32_16x16x32_bf16 v[184:187], a[156:159], v[64:67], v[184:187]
    s_waitcnt vmcnt(18)
    v_mfma_f32_16x16x32_bf16 v[188:191], a[144:147], v[68:71], v[188:191]
    v_mfma_f32_16x16x32_bf16 v[192:195], a[148:151], v[68:71], v[192:195]
    v_mfma_f32_16x16x32_bf16 v[196:199], a[152:155], v[68:71], v[196:199]
    v_mfma_f32_16x16x32_bf16 v[200:203], a[156:159], v[68:71], v[200:203]
    s_waitcnt vmcnt(17)
    v_mfma_f32_16x16x32_bf16 v[204:207], a[144:147], v[72:75], v[204:207]
    v_mfma_f32_16x16x32_bf16 v[208:211], a[148:151], v[72:75], v[208:211]
    v_mfma_f32_16x16x32_bf16 v[212:215], a[152:155], v[72:75], v[212:215]
    v_mfma_f32_16x16x32_bf16 v[216:219], a[156:159], v[72:75], v[216:219]
    s_waitcnt vmcnt(4)
    v_cmp_ne_u32_e64 vcc, s54, v15
    s_mov_b32 s81, 0x10000
    s_cbranch_vccz OK_10
POLL_9:
    s_sub_u32 s81, s81, 1
    s_cbranch_scc1 OK_10
    s_sleep 4
    buffer_load_dword v15, v14, s[16:19], s71 offen sc1
    s_waitcnt vmcnt(0)
    v_cmp_ne_u32_e64 vcc, s54, v15
    s_nop 1
    s_cbranch_vccnz POLL_9
OK_10:
    s_lshl_b32 s32, s28, 11
    s_add_u32 m0, s32, 147456
    s_nop 0
    buffer_load_dwordx4 v10, s[16:19], s70 offen offset:0 sc1 lds
    buffer_load_dwordx4 v21, s[16:19], s70 offen offset:1024 sc1 lds
    s_waitcnt lgkmcnt(15)
    v_mfma_f32_16x16x32_bf16 v[28:31], a[160:163], v[76:79], v[28:31]
    v_mfma_f32_16x16x32_bf16 v[32:35], a[164:167], v[76:79], v[32:35]
    v_mfma_f32_16x16x32_bf16 v[36:39], a[168:171], v[76:79], v[36:39]
    v_mfma_f32_16x16x32_bf16 v[40:43], a[172:175], v[76:79], v[40:43]
    v_mfma_f32_16x16x32_bf16 v[172:175], a[160:163], v[80:83], v[172:175]
    v_mfma_f32_16x16x32_bf16 v[176:179], a[164:167], v[80:83], v[176:179]
    v_mfma_f32_16x16x32_bf16 v[180:183], a[168:171], v[80:83], v[180:183]
    v_mfma_f32_16x16x32_bf16 v[184:187], a[172:175], v[80:83], v[184:187]
    v_mfma_f32_16x16x32_bf16 v[188:191], a[160:163], v[84:87], v[188:191]
    v_mfma_f32_16x16x32_bf16 v[192:195], a[164:167], v[84:87], v[192:195]
    v_mfma_f32_16x16x32_bf16 v[196:199], a[168:171], v[84:87], v[196:199]
    v_mfma_f32_16x16x32_bf16 v[200:203], a[172:175], v[84:87], v[200:203]
    v_mfma_f32_16x16x32_bf16 v[204:207], a[160:163], v[88:91], v[204:207]
    v_mfma_f32_16x16x32_bf16 v[208:211], a[164:167], v[88:91], v[208:211]
    v_mfma_f32_16x16x32_bf16 v[212:215], a[168:171], v[88:91], v[212:215]
    v_mfma_f32_16x16x32_bf16 v[216:219], a[172:175], v[88:91], v[216:219]
    v_mfma_f32_16x16x32_bf16 v[172:175], a[176:179], v[96:99], v[172:175]
    v_mfma_f32_16x16x32_bf16 v[176:179], a[180:183], v[96:99], v[176:179]
    v_mfma_f32_16x16x32_bf16 v[180:183], a[184:187], v[96:99], v[180:183]
    v_mfma_f32_16x16x32_bf16 v[184:187], a[188:191], v[96:99], v[184:187]
    s_waitcnt lgkmcnt(8)
    v_mfma_f32_16x16x32_bf16 v[172:175], a[192:195], v[112:115], v[172:175]
    v_mfma_f32_16x16x32_bf16 v[176:179], a[196:199], v[112:115], v[176:179]
    v_mfma_f32_16x16x32_bf16 v[180:183], a[200:203], v[112:115], v[180:183]
    v_mfma_f32_16x16x32_bf16 v[184:187], a[204:207], v[112:115], v[184:187]
    s_waitcnt lgkmcnt(0)
    s_waitcnt vmcnt(4)
    v_mfma_f32_16x16x32_bf16 v[172:175], a[208:211], v[128:131], v[172:175]
    v_mfma_f32_16x16x32_bf16 v[176:179], a[212:215], v[128:131], v[176:179]
    v_mfma_f32_16x16x32_bf16 v[180:183], a[216:219], v[128:131], v[180:183]
    v_mfma_f32_16x16x32_bf16 v[184:187], a[220:223], v[128:131], v[184:187]
    v_mfma_f32_16x16x32_bf16 v[188:191], a[176:179], v[100:103], v[188:191]
    v_mfma_f32_16x16x32_bf16 v[192:195], a[180:183], v[100:103], v[192:195]
    v_mfma_f32_16x16x32_bf16 v[196:199], a[184:187], v[100:103], v[196:199]
    v_mfma_f32_16x16x32_bf16 v[200:203], a[188:191], v[100:103], v[200:203]
    s_nop 0
    ds_write_b128 v18, v[172:175] offset:0
    v_mfma_f32_16x16x32_bf16 v[188:191], a[192:195], v[116:119], v[188:191]
    v_mfma_f32_16x16x32_bf16 v[192:195], a[196:199], v[116:119], v[192:195]
    v_mfma_f32_16x16x32_bf16 v[196:199], a[200:203], v[116:119], v[196:199]
    ds_write_b128 v18, v[176:179] offset:1024
    v_mfma_f32_16x16x32_bf16 v[200:203], a[204:207], v[116:119], v[200:203]
    s_waitcnt vmcnt(3)
    v_mfma_f32_16x16x32_bf16 v[188:191], a[208:211], v[132:135], v[188:191]
    v_mfma_f32_16x16x32_bf16 v[192:195], a[212:215], v[132:135], v[192:195]
    ds_write_b128 v18, v[180:183] offset:2048
    v_mfma_f32_16x16x32_bf16 v[196:199], a[216:219], v[132:135], v[196:199]
    v_mfma_f32_16x16x32_bf16 v[200:203], a[220:223], v[132:135], v[200:203]
    v_mfma_f32_16x16x32_bf16 v[204:207], a[176:179], v[104:107], v[204:207]
    ds_write_b128 v18, v[184:187] offset:3072
    v_mfma_f32_16x16x32_bf16 v[208:211], a[180:183], v[104:107], v[208:211]
    v_mfma_f32_16x16x32_bf16 v[212:215], a[184:187], v[104:107], v[212:215]
    v_mfma_f32_16x16x32_bf16 v[216:219], a[188:191], v[104:107], v[216:219]
    ds_write_b128 v19, v[188:191] offset:0
    v_mfma_f32_16x16x32_bf16 v[204:207], a[192:195], v[120:123], v[204:207]
    v_mfma_f32_16x16x32_bf16 v[208:211], a[196:199], v[120:123], v[208:211]
    v_mfma_f32_16x16x32_bf16 v[212:215], a[200:203], v[120:123], v[212:215]
    ds_write_b128 v19, v[192:195] offset:1024
    v_mfma_f32_16x16x32_bf16 v[216:219], a[204:207], v[120:123], v[216:219]
    s_waitcnt vmcnt(2)
    v_mfma_f32_16x16x32_bf16 v[204:207], a[208:211], v[136:139], v[204:207]
    v_mfma_f32_16x16x32_bf16 v[208:211], a[212:215], v[136:139], v[208:211]
    ds_write_b128 v19, v[196:199] offset:2048
    v_mfma_f32_16x16x32_bf16 v[212:215], a[216:219], v[136:139], v[212:215]
    v_mfma_f32_16x16x32_bf16 v[216:219], a[220:223], v[136:139], v[216:219]
    v_mfma_f32_16x16x32_bf16 v[28:31], a[176:179], v[92:95], v[28:31]
    ds_write_b128 v19, v[200:203] offset:3072
    v_mfma_f32_16x16x32_bf16 v[32:35], a[180:183], v[92:95], v[32:35]
    v_mfma_f32_16x16x32_bf16 v[36:39], a[184:187], v[92:95], v[36:39]
    v_mfma_f32_16x16x32_bf16 v[40:43], a[188:191], v[92:95], v[40:43]
    ds_write_b128 v20, v[204:207] offset:0
    v_mfma_f32_16x16x32_bf16 v[28:31], a[192:195], v[108:111], v[28:31]
    v_mfma_f32_16x16x32_bf16 v[32:35], a[196:199], v[108:111], v[32:35]
    v_mfma_f32_16x16x32_bf16 v[36:39], a[200:203], v[108:111], v[36:39]
    ds_write_b128 v20, v[208:211] offset:1024
    v_mfma_f32_16x16x32_bf16 v[40:43], a[204:207], v[108:111], v[40:43]
    v_mfma_f32_16x16x32_bf16 v[28:31], a[208:211], v[124:127], v[28:31]
    v_mfma_f32_16x16x32_bf16 v[32:35], a[212:215], v[124:127], v[32:35]
    ds_write_b128 v20, v[212:215] offset:2048
    v_mfma_f32_16x16x32_bf16 v[36:39], a[216:219], v[124:127], v[36:39]
    v_mfma_f32_16x16x32_bf16 v[40:43], a[220:223], v[124:127], v[40:43]
    ds_write_b128 v20, v[216:219] offset:3072
    s_waitcnt vmcnt(0)
    s_waitcnt lgkmcnt(0)
    s_barrier
    ds_read_b64 v[220:221], v8 offset:0
    ds_read_b64 v[222:223], v8 offset:512
    ds_read_b64 v[224:225], v8 offset:4096
    ds_read_b64 v[226:227], v8 offset:4608
    ds_read_b128 v[44:47], v9 offset:0
    ds_read_b128 v[48:51], v9 offset:4096
    ds_read_b128 v[52:55], v9 offset:8192
    ds_read_b128 v[56:59], v9 offset:1024
    ds_read_b128 v[60:63], v9 offset:5120
    ds_read_b128 v[64:67], v9 offset:9216
    ds_read_b128 v[68:71], v9 offset:2048
    ds_read_b128 v[72:75], v9 offset:6144
    ds_read_b128 v[76:79], v9 offset:10240
    ds_read_b128 v[80:83], v9 offset:3072
    ds_read_b128 v[84:87], v9 offset:7168
    ds_read_b128 v[88:91], v9 offset:11264
    s_waitcnt lgkmcnt(12)
    v_mfma_f32_16x16x16_bf16 v[28:31], v[220:221], v[16:17], v[28:31]
    v_mfma_f32_16x16x16_bf16 v[32:35], v[222:223], v[16:17], v[32:35]
    v_mfma_f32_16x16x16_bf16 v[36:39], v[224:225], v[16:17], v[36:39]
    v_mfma_f32_16x16x16_bf16 v[40:43], v[226:227], v[16:17], v[40:43]
    s_waitcnt lgkmcnt(9)
    s_nop 3
    v_pk_add_f32 v[28:29], v[28:29], v[44:45]
    v_pk_add_f32 v[48:49], v[48:49], v[52:53]
    v_pk_add_f32 v[30:31], v[30:31], v[46:47]
    v_pk_add_f32 v[50:51], v[50:51], v[54:55]
    v_pk_add_f32 v[28:29], v[28:29], v[48:49]
    v_pk_add_f32 v[30:31], v[30:31], v[50:51]
    v_cvt_pk_bf16_f32 v92, v28, v29
    v_cvt_pk_bf16_f32 v93, v30, v31
    s_waitcnt lgkmcnt(6)
    s_nop 0
    v_pk_add_f32 v[32:33], v[32:33], v[56:57]
    v_pk_add_f32 v[60:61], v[60:61], v[64:65]
    v_pk_add_f32 v[34:35], v[34:35], v[58:59]
    v_pk_add_f32 v[62:63], v[62:63], v[66:67]
    v_pk_add_f32 v[32:33], v[32:33], v[60:61]
    v_pk_add_f32 v[34:35], v[34:35], v[62:63]
    v_cvt_pk_bf16_f32 v94, v32, v33
    v_cvt_pk_bf16_f32 v95, v34, v35
    buffer_store_dwordx4 v[92:95], v11, s[20:23], 0 offen offset:0
    s_waitcnt lgkmcnt(3)
    s_nop 0
    v_pk_add_f32 v[36:37], v[36:37], v[68:69]
    v_pk_add_f32 v[72:73], v[72:73], v[76:77]
    v_pk_add_f32 v[38:39], v[38:39], v[70:71]
    v_pk_add_f32 v[74:75], v[74:75], v[78:79]
    v_pk_add_f32 v[36:37], v[36:37], v[72:73]
    v_pk_add_f32 v[38:39], v[38:39], v[74:75]
    v_cvt_pk_bf16_f32 v96, v36, v37
    v_cvt_pk_bf16_f32 v97, v38, v39
    s_waitcnt lgkmcnt(0)
    s_nop 0
    v_pk_add_f32 v[40:41], v[40:41], v[80:81]
    v_pk_add_f32 v[84:85], v[84:85], v[88:89]
    v_pk_add_f32 v[42:43], v[42:43], v[82:83]
    v_pk_add_f32 v[86:87], v[86:87], v[90:91]
    v_pk_add_f32 v[40:41], v[40:41], v[84:85]
    v_pk_add_f32 v[42:43], v[42:43], v[86:87]
    v_cvt_pk_bf16_f32 v98, v40, v41
    v_cvt_pk_bf16_f32 v99, v42, v43
    buffer_store_dwordx4 v[96:99], v11, s[20:23], 0 offen offset:64
    s_endpgm
HELPER_2:
    s_lshl_b32 s31, s29, 2
    s_add_u32 s31, s31, s30
    s_sub_u32 s70, s31, 28
    s_and_b32 s76, s70, 15
    s_min_u32 s76, s76, 13
    s_lshr_b32 s31, s70, 4
    s_mul_i32 s31, s31, 14
    s_add_u32 s76, s76, s31
    s_lshl_b32 s76, s76, 7
    s_mul_i32 s31, s28, 458752
    s_add_u32 s73, s31, s76
    v_lshrrev_b32 v28, 3, v1
    v_mul_u32_u24 v28, 3584, v28
    v_lshlrev_b32 v29, 1, v3
    v_and_b32 v30, 7, v0
    v_xor_b32_e64 v29, v29, v30
    v_lshl_add_u32 v30, v29, 4, v28
    v_add_u32 v31, 27648, v30
    v_add_u32 v32, 55296, v30
    v_add_u32 v33, 82944, v30
    s_lshl_b32 s75, s28, 14
    s_add_u32 m0, s75, 0
    s_nop 0
    buffer_load_dwordx4 v30, s[8:11], s73 offen offset:0 lds
    buffer_load_dwordx4 v31, s[8:11], s73 offen offset:1024 lds
    buffer_load_dwordx4 v32, s[8:11], s73 offen offset:2048 lds
    buffer_load_dwordx4 v33, s[8:11], s73 offen offset:3072 lds
    s_add_u32 s73, s73, 114688
    s_add_u32 m0, s75, 4096
    s_nop 0
    buffer_load_dwordx4 v30, s[8:11], s73 offen offset:0 lds
    buffer_load_dwordx4 v31, s[8:11], s73 offen offset:1024 lds
    buffer_load_dwordx4 v32, s[8:11], s73 offen offset:2048 lds
    buffer_load_dwordx4 v33, s[8:11], s73 offen offset:3072 lds
    s_add_u32 s73, s73, 114688
    s_add_u32 m0, s75, 8192
    s_nop 0
    buffer_load_dwordx4 v30, s[8:11], s73 offen offset:0 lds
    buffer_load_dwordx4 v31, s[8:11], s73 offen offset:1024 lds
    buffer_load_dwordx4 v32, s[8:11], s73 offen offset:2048 lds
    buffer_load_dwordx4 v33, s[8:11], s73 offen offset:3072 lds
    s_add_u32 s73, s73, 114688
    s_add_u32 m0, s75, 12288
    s_nop 0
    buffer_load_dwordx4 v30, s[8:11], s73 offen offset:0 lds
    buffer_load_dwordx4 v31, s[8:11], s73 offen offset:1024 lds
    buffer_load_dwordx4 v32, s[8:11], s73 offen offset:2048 lds
    buffer_load_dwordx4 v33, s[8:11], s73 offen offset:3072 lds
    s_add_u32 s73, s73, 114688
    s_lshl_b32 s31, s28, 5
    s_add_u32 s76, s76, s31
    v_lshl_add_u32 v28, v2, 1, s76
    global_load_ushort v34, v28, s[58:59]
    s_mov_b32 s31, 0x3f803f80
    s_mul_i32 s32, s28, 2304
    s_add_u32 s32, s32, 132096
    v_add_u32 v52, s32, v6
    s_lshr_b32 s32, s77, 6
    s_add_u32 s32, s32, 0xb10000
    v_and_b32 v35, 31, v0
    v_lshrrev_b32 v44, 1, v1
    v_lshl_add_u32 v44, v35, 26, v44
    v_mov_b32 v43, 0
    s_waitcnt vmcnt(25)
    v_dot2_f32_bf16 v36, v8, s31, 0
    v_dot2_f32_bf16 v38, v8, v8, 0
    v_dot2_f32_bf16 v37, v12, s31, 0
    v_dot2_f32_bf16 v39, v12, v12, 0
    v_dot2_f32_bf16 v36, v9, s31, v36
    v_dot2_f32_bf16 v38, v9, v9, v38
    v_dot2_f32_bf16 v37, v13, s31, v37
    v_dot2_f32_bf16 v39, v13, v13, v39
    v_dot2_f32_bf16 v36, v10, s31, v36
    v_dot2_f32_bf16 v38, v10, v10, v38
    v_dot2_f32_bf16 v37, v14, s31, v37
    v_dot2_f32_bf16 v39, v14, v14, v39
    v_dot2_f32_bf16 v36, v11, s31, v36
    v_dot2_f32_bf16 v38, v11, v11, v38
    v_dot2_f32_bf16 v37, v15, s31, v37
    v_dot2_f32_bf16 v39, v15, v15, v39
    s_nop 1
    v_permlane32_swap_b32 v36, v37
    v_permlane32_swap_b32 v38, v39
    v_add_f32 v36, v36, v37
    v_add_f32 v38, v38, v39
    s_nop 1
    v_permlane16_swap_b32 v36, v38
    v_add_f32 v36, v36, v38
    v_lshlrev_b32_e64 v54, 16, v8
    v_and_b32 v55, 0xffff0000, v8
    v_add_f32_dpp v36, v36, v36 row_ror:8 row_mask:0xf bank_mask:0xf
    v_lshlrev_b32_e64 v56, 16, v9
    v_and_b32 v57, 0xffff0000, v9
    v_add_f32_dpp v36, v36, v36 row_ror:4 row_mask:0xf bank_mask:0xf
    v_lshlrev_b32_e64 v58, 16, v10
    v_and_b32 v59, 0xffff0000, v10
    v_add_f32_dpp v36, v36, v36 row_ror:2 row_mask:0xf bank_mask:0xf
    v_lshlrev_b32_e64 v60, 16, v11
    v_and_b32 v61, 0xffff0000, v11
    v_add_f32_dpp v36, v36, v36 row_ror:1 row_mask:0xf bank_mask:0xf
    v_mov_b32 v38, v36
    v_lshlrev_b32 v62, 16, v12
    v_and_b32 v63, 0xffff0000, v12
    v_permlane16_swap_b32 v36, v38
    s_nop 0
    v_mul_f32 v37, 0x3b000000, v36
    v_mul_f32_e64 v35, v37, v37
    v_mul_f32 v41, 0x3b000000, v38
    v_sub_f32 v41, v41, v35
    v_max_f32 v41, 0, v41
    v_cvt_pk_bf16_f32 v35, v37, v41
    v_lshlrev_b32_e64 v37, 16, v35
    v_and_b32 v41, 0xffff0000, v35
    v_add_f32 v41, 0x3727c5ac, v41
    v_cvt_pk_bf16_f32 v41, v41, v41
    v_lshlrev_b32 v41, 16, v41
    v_sqrt_f32_e64 v41, v41
    s_nop 0
    v_cvt_pk_bf16_f32 v41, v41, v41
    v_lshlrev_b32 v41, 16, v41
    v_rcp_f32 v42, v41
    v_lshlrev_b32_e64 v64, 16, v13
    v_and_b32 v65, 0xffff0000, v13
    v_lshlrev_b32_e64 v66, 16, v14
    v_and_b32 v67, 0xffff0000, v14
    v_lshlrev_b32_e64 v68, 16, v15
    v_and_b32 v69, 0xffff0000, v15
    v_mul_f32_e64 v35, v37, v42
    v_cvt_pk_bf16_f32 v40, -v37, -v37
    v_lshrrev_b32_e64 v41, 16, v41
    v_readlane_b32 s34, v42, 0
    v_readlane_b32 s35, v35, 0
    v_readlane_b32 vcc_lo, v42, 32
    v_readlane_b32 vcc_hi, v35, 32
    buffer_store_dwordx4 v[40:43], v44, s[16:19], s32 offen sc1
    v_pk_fma_f32 v[54:55], v[54:55], s[34:35], s[34:35] op_sel:[0,0,1] op_sel_hi:[1,0,1] neg_lo:[0,0,1] neg_hi:[0,0,1]
    v_pk_fma_f32 v[56:57], v[56:57], s[34:35], s[34:35] op_sel:[0,0,1] op_sel_hi:[1,0,1] neg_lo:[0,0,1] neg_hi:[0,0,1]
    v_pk_fma_f32 v[58:59], v[58:59], s[34:35], s[34:35] op_sel:[0,0,1] op_sel_hi:[1,0,1] neg_lo:[0,0,1] neg_hi:[0,0,1]
    v_pk_fma_f32 v[60:61], v[60:61], s[34:35], s[34:35] op_sel:[0,0,1] op_sel_hi:[1,0,1] neg_lo:[0,0,1] neg_hi:[0,0,1]
    v_cvt_pk_bf16_f32 v8, v54, v55
    v_cvt_pk_bf16_f32 v9, v56, v57
    v_cvt_pk_bf16_f32 v10, v58, v59
    v_cvt_pk_bf16_f32 v11, v60, v61
    ds_write_b128 v52, v[8:11] offset:0
    v_pk_fma_f32 v[62:63], v[62:63], vcc, vcc op_sel:[0,0,1] op_sel_hi:[1,0,1] neg_lo:[0,0,1] neg_hi:[0,0,1]
    v_pk_fma_f32 v[64:65], v[64:65], vcc, vcc op_sel:[0,0,1] op_sel_hi:[1,0,1] neg_lo:[0,0,1] neg_hi:[0,0,1]
    v_pk_fma_f32 v[66:67], v[66:67], vcc, vcc op_sel:[0,0,1] op_sel_hi:[1,0,1] neg_lo:[0,0,1] neg_hi:[0,0,1]
    v_pk_fma_f32 v[68:69], v[68:69], vcc, vcc op_sel:[0,0,1] op_sel_hi:[1,0,1] neg_lo:[0,0,1] neg_hi:[0,0,1]
    v_cvt_pk_bf16_f32 v12, v62, v63
    v_cvt_pk_bf16_f32 v13, v64, v65
    v_cvt_pk_bf16_f32 v14, v66, v67
    v_cvt_pk_bf16_f32 v15, v68, v69
    ds_write_b128 v52, v[12:15] offset:1152
    s_lshl_b32 s34, s28, 8
    s_add_u32 s34, s34, 132096
    s_nop 0
    v_mul_u32_u24 v35, 1152, v4
    v_lshl_add_u32 v35, v3, 5, v35
    v_lshl_add_u32 v35, v5, 3, v35
    v_add_u32_e64 v35, s34, v35
    s_waitcnt lgkmcnt(0)
    s_barrier
    s_add_u32 s54, s54, 0x9e3779b9
    ds_read_b64_tr_b16 v[8:9], v35 offset:0
    ds_read_b64_tr_b16 v[10:11], v35 offset:4608
    ds_read_b64_tr_b16 v[12:13], v35 offset:128
    ds_read_b64_tr_b16 v[14:15], v35 offset:4736
    s_add_u32 s77, s77, 0x700000
    s_waitcnt lgkmcnt(0)
    buffer_store_dwordx4 v[8:11], v6, s[16:19], s77 offen offset:0 sc1
    buffer_store_dwordx4 v[12:15], v6, s[16:19], s77 offen offset:1024 sc1
    s_lshl_b32 s31, s30, 8
    v_add_u32_e64 v35, s31, v0
    s_lshl_b32 s33, s2, 2
    s_add_u32 s33, s33, s28
    s_mul_i32 s33, s33, 896
    s_add_u32 s33, s33, 917504
    v_min_u32 v36, 6, v1
    v_lshlrev_b32 v36, 7, v36
    buffer_load_dword v255, v36, s[8:11], s33 offen
    s_lshl_b32 s33, s2, 2
    s_add_u32 s33, s33, s28
    s_mul_i32 s33, s33, 1792
    v_min_u32 v36, 13, v1
    v_lshlrev_b32 v36, 7, v36
    buffer_load_dword v255, v36, s[12:15], s33 offen
    s_lshl_b32 s33, s80, 7
    v_mov_b32 v36, s33
    global_load_dword v255, v36, s[62:63]
    v_mov_b32 v36, 0x3f803f80
    v_mov_b32 v37, 0x3f803f80
    v_mov_b32 v38, 0x3f803f80
    v_mov_b32 v39, 0x3f803f80
    v_lshl_add_u32 v28, v3, 2, v4
    v_bfe_u32 v29, v28, 1, 2
    v_xor_b32 v29, s28, v29
    v_lshlrev_b32 v29, 5, v29
    v_lshl_add_u32 v28, v28, 7, v29
    v_lshl_add_u32 v28, v5, 3, v28
    v_add_u32_e64 v28, 0, v28
    s_waitcnt vmcnt(6)
    s_barrier
    ds_read_b64_tr_b16 a[0:1], v28 offset:0
    ds_read_b64_tr_b16 a[2:3], v28 offset:2048
    ds_read_b64_tr_b16 a[4:5], v28 offset:4096
    ds_read_b64_tr_b16 a[6:7], v28 offset:6144
    ds_read_b64_tr_b16 a[8:9], v28 offset:8192
    ds_read_b64_tr_b16 a[10:11], v28 offset:10240
    ds_read_b64_tr_b16 a[12:13], v28 offset:12288
    ds_read_b64_tr_b16 a[14:15], v28 offset:14336
    ds_read_b64_tr_b16 a[16:17], v28 offset:16384
    ds_read_b64_tr_b16 a[18:19], v28 offset:18432
    s_waitcnt lgkmcnt(8)
    v_mfma_f32_16x16x32_bf16 v[40:43], v[36:39], a[0:3], 0
    ds_read_b64_tr_b16 a[20:21], v28 offset:20480
    ds_read_b64_tr_b16 a[22:23], v28 offset:22528
    s_waitcnt lgkmcnt(8)
    v_mfma_f32_16x16x32_bf16 v[40:43], v[36:39], a[4:7], v[40:43]
    ds_read_b64_tr_b16 a[24:25], v28 offset:24576
    ds_read_b64_tr_b16 a[26:27], v28 offset:26624
    s_waitcnt lgkmcnt(8)
    v_mfma_f32_16x16x32_bf16 v[40:43], v[36:39], a[8:11], v[40:43]
    ds_read_b64_tr_b16 a[28:29], v28 offset:28672
    ds_read_b64_tr_b16 a[30:31], v28 offset:30720
    s_waitcnt lgkmcnt(8)
    v_mfma_f32_16x16x32_bf16 v[40:43], v[36:39], a[12:15], v[40:43]
    ds_read_b64_tr_b16 a[32:33], v28 offset:32768
    ds_read_b64_tr_b16 a[34:35], v28 offset:34816
    s_waitcnt lgkmcnt(8)
    v_mfma_f32_16x16x32_bf16 v[40:43], v[36:39], a[16:19], v[40:43]
    ds_read_b64_tr_b16 a[36:37], v28 offset:36864
    ds_read_b64_tr_b16 a[38:39], v28 offset:38912
    s_waitcnt lgkmcnt(8)
    v_mfma_f32_16x16x32_bf16 v[40:43], v[36:39], a[20:23], v[40:43]
    ds_read_b64_tr_b16 a[40:41], v28 offset:40960
    ds_read_b64_tr_b16 a[42:43], v28 offset:43008
    s_waitcnt lgkmcnt(8)
    v_mfma_f32_16x16x32_bf16 v[40:43], v[36:39], a[24:27], v[40:43]
    ds_read_b64_tr_b16 a[44:45], v28 offset:45056
    ds_read_b64_tr_b16 a[46:47], v28 offset:47104
    s_waitcnt lgkmcnt(8)
    v_mfma_f32_16x16x32_bf16 v[40:43], v[36:39], a[28:31], v[40:43]
    ds_read_b64_tr_b16 a[48:49], v28 offset:49152
    ds_read_b64_tr_b16 a[50:51], v28 offset:51200
    s_waitcnt lgkmcnt(8)
    v_mfma_f32_16x16x32_bf16 v[40:43], v[36:39], a[32:35], v[40:43]
    ds_read_b64_tr_b16 a[52:53], v28 offset:53248
    ds_read_b64_tr_b16 a[54:55], v28 offset:55296
    s_waitcnt lgkmcnt(8)
    v_mfma_f32_16x16x32_bf16 v[40:43], v[36:39], a[36:39], v[40:43]
    ds_read_b64_tr_b16 a[56:57], v28 offset:57344
    ds_read_b64_tr_b16 a[58:59], v28 offset:59392
    s_waitcnt lgkmcnt(8)
    v_mfma_f32_16x16x32_bf16 v[40:43], v[36:39], a[40:43], v[40:43]
    ds_read_b64_tr_b16 a[60:61], v28 offset:61440
    ds_read_b64_tr_b16 a[62:63], v28 offset:63488
    s_waitcnt lgkmcnt(8)
    v_mfma_f32_16x16x32_bf16 v[40:43], v[36:39], a[44:47], v[40:43]
    s_waitcnt lgkmcnt(6)
    v_mfma_f32_16x16x32_bf16 v[40:43], v[36:39], a[48:51], v[40:43]
    s_waitcnt lgkmcnt(4)
    v_mfma_f32_16x16x32_bf16 v[40:43], v[36:39], a[52:55], v[40:43]
    s_waitcnt lgkmcnt(2)
    v_mfma_f32_16x16x32_bf16 v[40:43], v[36:39], a[56:59], v[40:43]
    s_waitcnt lgkmcnt(0)
    v_mfma_f32_16x16x32_bf16 v[40:43], v[36:39], a[60:63], v[40:43]
    s_lshl_b32 s31, s76, 2
    s_add_u32 s31, s31, 0xb20000
    v_lshlrev_b32 v29, 28, v3
    v_lshl_add_u32 v29, v2, 3, v29
    s_nop 3
    s_nop 0
    v_cvt_pk_bf16_f32 v44, v40, v40
    v_lshlrev_b32 v44, 16, v44
    v_sub_f32 v28, v40, v44
    v_cvt_pk_bf16_f32 v44, v44, v28
    v_mov_b32_e64 v45, v34
    buffer_store_dwordx2 v[44:45], v29, s[16:19], s31 offen sc1
    s_waitcnt vmcnt(0)
    s_barrier
    s_lshr_b32 s31, s2, 4
    s_lshl_b32 s31, s31, 8
    s_and_b32 s32, s2, 15
    s_lshl_b32 s32, s32, 2
    s_add_u32 s31, s31, s32
    s_add_u32 s31, s31, 0xb00000
    v_lshlrev_b32 v28, 24, v0
    v_mov_b32_e64 v29, s54
    buffer_store_dword v29, v28, s[16:19], s31 offen sc1
    v_lshrrev_b32 v246, 3, v1
    v_lshlrev_b32 v246, 10, v246
    v_and_b32 v250, 1, v3
    v_lshlrev_b32 v250, 2, v250
    v_and_b32 v251, 7, v1
    v_xor_b32 v250, v250, v251
    v_lshl_add_u32 v246, v250, 4, v246
    s_lshl_b32 s3, s80, 7
    v_add_u32 v246, s3, v246
    v_add_u32 v247, 7168, v246
    v_add_u32 v248, 14336, v246
    v_add_u32 v249, 21504, v246
    s_lshl_b32 s3, s28, 13
    s_mul_i32 s75, s28, 458752
    s_add_u32 s25, s75, 458752
    s_lshl_b32 s26, s24, 15
    s_add_u32 s75, s75, s26
    s_nop 0
    v_lshl_add_u32 v250, v3, 2, v4
    v_lshlrev_b32_e64 v250, 7, v250
    v_lshl_add_u32 v250, v5, 4, v250
    v_add_u32 v250, s3, v250
    v_and_b32 v251, 2, v4
    v_lshl_add_u32 v250, v251, 5, v250
    v_xor_b32_e64 v251, 64, v250
    v_add_u32 v252, 0x10000, v250
    v_add_u32 v253, 0x10000, v251
    s_mul_i32 s35, s28, 4608
    s_add_u32 s35, s35, 141312
    v_lshl_add_u32 v33, v1, 2, s35
    v_mul_u32_u24 v34, 288, v2
    v_lshl_add_u32 v34, v3, 4, v34
    v_add_u32 v34, s35, v34
    v_add_u32 v32, s35, v6
    v_add_u32_e64 v36, 0, v33
    v_add_u32 v37, 1152, v33
    v_add_u32 v38, 2304, v33
    v_add_u32 v39, 3456, v33
    s_mov_b32 s31, 0x3fb8aa3b
    s_mov_b32 s32, 0x32a57060
    v_lshlrev_b32 v24, 16, v24
    v_lshlrev_b32 v25, 16, v25
    v_mul_f32_e64 v28, s31, v24
    v_fma_f32 v29, v24, s31, -v28
    v_exp_f32_e64 v28, v28
    v_fma_f32 v29, v24, s32, v29
    v_lshlrev_b32 v16, 16, v16
    v_lshlrev_b32 v17, 16, v17
    v_lshlrev_b32 v18, 16, v18
    v_lshlrev_b32 v19, 16, v19
    v_lshlrev_b32 v20, 16, v20
    v_lshlrev_b32 v21, 16, v21
    v_mul_f32 v29, 0x3f317218, v29
    v_fma_f32 v28, v28, v29, v28
    v_cvt_pk_bf16_f32 v28, v28, v28
    v_lshlrev_b32_e64 v24, 16, v28
    v_pk_mul_f32 v[16:17], v[16:17], v[24:25] op_sel_hi:[1,0]
    v_pk_mul_f32 v[18:19], v[18:19], v[24:25] op_sel_hi:[1,0]
    v_mul_f32 v16, s31, v16
    v_mul_f32 v17, 0.15915494, v17
    v_mul_f32 v40, 1.0, v16
    v_mul_f32 v41, 1.0, v17
    v_mul_f32 v42, 0x41000000, v16
    v_mul_f32 v43, 0x41000000, v17
    v_mul_f32 v44, 0x43800000, v16
    v_mul_f32 v45, 0x43800000, v17
    v_fract_f32 v41, v41
    v_exp_f32 v40, v40
    v_fract_f32 v43, v43
    v_exp_f32 v42, v42
    v_fract_f32 v45, v45
    v_exp_f32 v44, v44
    v_cos_f32 v52, v41
    v_sin_f32 v53, v41
    v_cos_f32 v54, v43
    v_sin_f32 v55, v43
    v_cos_f32 v56, v45
    v_sin_f32 v57, v45
    v_pk_mul_f32 v[52:53], v[52:53], v[40:41] op_sel_hi:[1,0]
    v_pk_mul_f32 v[54:55], v[54:55], v[42:43] op_sel_hi:[1,0]
    v_pk_mul_f32 v[56:57], v[56:57], v[44:45] op_sel_hi:[1,0]
    v_mov_b32 v30, 0x3f80
    ds_write_b32 v33, v30
    v_pk_mul_f32 v[40:41], v[52:53], v[52:53] op_sel_hi:[0,1]
    v_pk_mul_f32 v[42:43], v[56:57], v[56:57] op_sel_hi:[0,1]
    v_pk_fma_f32 v[74:75], v[52:53], v[52:53], v[40:41] op_sel:[1,1,0] op_sel_hi:[1,0,1] neg_lo:[0,1,0]
    v_pk_fma_f32 v[76:77], v[56:57], v[56:57], v[42:43] op_sel:[1,1,0] op_sel_hi:[1,0,1] neg_lo:[0,1,0]
    v_cvt_pk_bf16_f32 v35, v74, v75
    v_cvt_pk_bf16_f32 v48, v76, v77
    v_cvt_pk_bf16_f32 v49, v52, v53
    v_cvt_pk_bf16_f32 v50, v56, v57
    ds_write2_b32 v36, v35, v49 offset0:144 offset1:72
    ds_write_b32 v33, v48 offset:2304
    ds_write_b32 v33, v50 offset:1152
    v_pk_mul_f32 v[40:41], v[74:75], v[74:75] op_sel_hi:[0,1]
    v_pk_mul_f32 v[42:43], v[76:77], v[76:77] op_sel_hi:[0,1]
    v_pk_mul_f32 v[44:45], v[74:75], v[52:53] op_sel_hi:[0,1]
    v_pk_mul_f32 v[46:47], v[56:57], v[74:75] op_sel_hi:[0,1]
    v_pk_fma_f32 v[78:79], v[74:75], v[74:75], v[40:41] op_sel:[1,1,0] op_sel_hi:[1,0,1] neg_lo:[0,1,0]
    v_pk_fma_f32 v[80:81], v[76:77], v[76:77], v[42:43] op_sel:[1,1,0] op_sel_hi:[1,0,1] neg_lo:[0,1,0]
    v_pk_fma_f32 v[82:83], v[74:75], v[52:53], v[44:45] op_sel:[1,1,0] op_sel_hi:[1,0,1] neg_lo:[0,1,0]
    v_pk_fma_f32 v[58:59], v[56:57], v[74:75], v[46:47] op_sel:[1,1,0] op_sel_hi:[1,0,1] neg_lo:[0,1,0]
    v_cvt_pk_bf16_f32 v48, v80, v81
    v_cvt_pk_bf16_f32 v49, v82, v83
    v_cvt_pk_bf16_f32 v50, v58, v59
    ds_write_b32 v33, v48 offset:3456
    ds_write_b32 v33, v49 offset:864
    ds_write_b32 v33, v50 offset:1440
    v_pk_mul_f32 v[40:41], v[78:79], v[74:75] op_sel_hi:[0,1]
    v_pk_mul_f32 v[42:43], v[80:81], v[56:57] op_sel_hi:[0,1]
    v_pk_mul_f32 v[44:45], v[56:57], v[78:79] op_sel_hi:[0,1]
    v_pk_mul_f32 v[46:47], v[76:77], v[78:79] op_sel_hi:[0,1]
    v_pk_fma_f32 v[84:85], v[78:79], v[74:75], v[40:41] op_sel:[1,1,0] op_sel_hi:[1,0,1] neg_lo:[0,1,0]
    v_pk_fma_f32 v[86:87], v[80:81], v[56:57], v[42:43] op_sel:[1,1,0] op_sel_hi:[1,0,1] neg_lo:[0,1,0]
    v_pk_fma_f32 v[58:59], v[56:57], v[78:79], v[44:45] op_sel:[1,1,0] op_sel_hi:[1,0,1] neg_lo:[0,1,0]
    v_pk_fma_f32 v[60:61], v[76:77], v[78:79], v[46:47] op_sel:[1,1,0] op_sel_hi:[1,0,1] neg_lo:[0,1,0]
    v_cvt_pk_bf16_f32 v48, v86, v87
    v_cvt_pk_bf16_f32 v49, v58, v59
    v_cvt_pk_bf16_f32 v50, v60, v61
    ds_write_b32 v33, v48 offset:4032
    ds_write_b32 v33, v49 offset:1728
    ds_write_b32 v33, v50 offset:2592
    v_pk_mul_f32 v[40:41], v[56:57], v[84:85] op_sel_hi:[0,1]
    v_pk_mul_f32 v[42:43], v[76:77], v[54:55] op_sel_hi:[0,1]
    v_pk_mul_f32 v[44:45], v[80:81], v[54:55] op_sel_hi:[0,1]
    v_pk_mul_f32 v[46:47], v[86:87], v[54:55] op_sel_hi:[0,1]
    v_pk_fma_f32 v[58:59], v[56:57], v[84:85], v[40:41] op_sel:[1,1,0] op_sel_hi:[1,0,1] neg_lo:[0,1,0]
    v_pk_fma_f32 v[60:61], v[76:77], v[54:55], v[42:43] op_sel:[1,1,0] op_sel_hi:[1,0,1] neg_lo:[0,1,0]
    v_pk_fma_f32 v[62:63], v[80:81], v[54:55], v[44:45] op_sel:[1,1,0] op_sel_hi:[1,0,1] neg_lo:[0,1,0]
    v_pk_fma_f32 v[64:65], v[86:87], v[54:55], v[46:47] op_sel:[1,1,0] op_sel_hi:[1,0,1] neg_lo:[0,1,0]
    v_cvt_pk_bf16_f32 v35, v58, v59
    v_cvt_pk_bf16_f32 v48, v60, v61
    v_cvt_pk_bf16_f32 v49, v62, v63
    v_cvt_pk_bf16_f32 v50, v64, v65
    ds_write_b32 v33, v35 offset:2016
    ds_write_b32 v33, v48 offset:2880
    ds_write2_b32 v39, v49, v50 offset0:72 offset1:216
    ds_read_b128 a[0:3], v34 offset:0
    ds_read_b128 a[4:7], v34 offset:64
    ds_read_b128 a[8:11], v34 offset:128
    ds_read_b128 a[12:15], v34 offset:192
    v_pk_mul_f32 v[40:41], v[76:77], v[56:57] op_sel_hi:[0,1]
    v_pk_mul_f32 v[42:43], v[80:81], v[76:77] op_sel_hi:[0,1]
    v_pk_fma_f32 v[88:89], v[76:77], v[56:57], v[40:41] op_sel:[1,1,0] op_sel_hi:[1,0,1] neg_lo:[0,1,0]
    v_pk_fma_f32 v[90:91], v[80:81], v[76:77], v[42:43] op_sel:[1,1,0] op_sel_hi:[1,0,1] neg_lo:[0,1,0]
    v_cvt_pk_bf16_f32 v35, v88, v89
    v_cvt_pk_bf16_f32 v48, v90, v91
    v_cvt_pk_bf16_f32 v49, v78, v79
    v_cvt_pk_bf16_f32 v50, v84, v85
    ds_write_b32 v33, v35 offset:2304
    ds_write_b32 v33, v48 offset:3456
    ds_write2_b32 v36, v49, v50 offset0:0 offset1:144
    v_pk_mul_f32 v[40:41], v[80:81], v[88:89] op_sel_hi:[0,1]
    v_pk_mul_f32 v[42:43], v[78:79], v[52:53] op_sel_hi:[0,1]
    v_pk_mul_f32 v[44:45], v[78:79], v[82:83] op_sel_hi:[0,1]
    v_pk_mul_f32 v[46:47], v[56:57], v[54:55] op_sel_hi:[0,1]
    v_pk_fma_f32 v[92:93], v[80:81], v[88:89], v[40:41] op_sel:[1,1,0] op_sel_hi:[1,0,1] neg_lo:[0,1,0]
    v_pk_fma_f32 v[60:61], v[78:79], v[52:53], v[42:43] op_sel:[1,1,0] op_sel_hi:[1,0,1] neg_lo:[0,1,0]
    v_pk_fma_f32 v[62:63], v[78:79], v[82:83], v[44:45] op_sel:[1,1,0] op_sel_hi:[1,0,1] neg_lo:[0,1,0]
    v_pk_fma_f32 v[64:65], v[56:57], v[54:55], v[46:47] op_sel:[1,1,0] op_sel_hi:[1,0,1] neg_lo:[0,1,0]
    v_cvt_pk_bf16_f32 v35, v92, v93
    v_cvt_pk_bf16_f32 v48, v60, v61
    v_cvt_pk_bf16_f32 v49, v62, v63
    v_cvt_pk_bf16_f32 v50, v64, v65
    ds_write_b32 v33, v35 offset:4032
    ds_write2_b32 v36, v48, v49 offset0:72 offset1:216
    ds_write_b32 v33, v50 offset:1152
    v_pk_mul_f32 v[40:41], v[88:89], v[78:79] op_sel_hi:[0,1]
    v_pk_mul_f32 v[42:43], v[88:89], v[54:55] op_sel_hi:[0,1]
    v_pk_mul_f32 v[44:45], v[90:91], v[54:55] op_sel_hi:[0,1]
    v_pk_mul_f32 v[46:47], v[92:93], v[54:55] op_sel_hi:[0,1]
    v_pk_fma_f32 v[58:59], v[88:89], v[78:79], v[40:41] op_sel:[1,1,0] op_sel_hi:[1,0,1] neg_lo:[0,1,0]
    v_pk_fma_f32 v[60:61], v[88:89], v[54:55], v[42:43] op_sel:[1,1,0] op_sel_hi:[1,0,1] neg_lo:[0,1,0]
    v_pk_fma_f32 v[62:63], v[90:91], v[54:55], v[44:45] op_sel:[1,1,0] op_sel_hi:[1,0,1] neg_lo:[0,1,0]
    v_pk_fma_f32 v[64:65], v[92:93], v[54:55], v[46:47] op_sel:[1,1,0] op_sel_hi:[1,0,1] neg_lo:[0,1,0]
    v_cvt_pk_bf16_f32 v35, v58, v59
    v_cvt_pk_bf16_f32 v48, v60, v61
    v_cvt_pk_bf16_f32 v49, v62, v63
    v_cvt_pk_bf16_f32 v50, v64, v65
    ds_write2_b32 v38, v35, v48 offset0:72 offset1:144
    ds_write2_b32 v39, v49, v50 offset0:72 offset1:216
    ds_read_b128 a[16:19], v34 offset:0
    ds_read_b128 a[20:23], v34 offset:64
    ds_read_b128 a[24:27], v34 offset:128
    ds_read_b128 a[28:31], v34 offset:192
    v_pk_mul_f32 v[40:41], v[20:21], v[18:19] op_sel_hi:[0,1]
    v_pk_mul_f32 v[42:43], v[54:55], v[54:55] op_sel_hi:[0,1]
    v_pk_fma_f32 v[66:67], v[20:21], v[18:19], v[40:41] op_sel:[1,1,0] op_sel_hi:[1,0,1] neg_lo:[0,1,0]
    v_pk_fma_f32 v[94:95], v[54:55], v[54:55], v[42:43] op_sel:[1,1,0] op_sel_hi:[1,0,1] neg_lo:[0,1,0]
    v_cvt_pk_bf16_f32 v35, v66, -v67
    ds_write_b32 v33, v35 offset:0
    v_pk_mul_f32 v[40:41], v[66:67], v[54:55] op_sel_hi:[0,1]
    v_pk_mul_f32 v[42:43], v[94:95], v[94:95] op_sel_hi:[0,1]
    v_pk_mul_f32 v[44:45], v[66:67], v[94:95] op_sel_hi:[0,1]
    v_pk_fma_f32 v[68:69], v[66:67], v[54:55], v[40:41] op_sel:[1,1,0] op_sel_hi:[1,0,1] neg_lo:[0,1,0]
    v_pk_fma_f32 v[96:97], v[94:95], v[94:95], v[42:43] op_sel:[1,1,0] op_sel_hi:[1,0,1] neg_lo:[0,1,0]
    v_pk_fma_f32 v[70:71], v[66:67], v[94:95], v[44:45] op_sel:[1,1,0] op_sel_hi:[1,0,1] neg_lo:[0,1,0]
    v_cvt_pk_bf16_f32 v35, v68, -v69
    v_cvt_pk_bf16_f32 v49, v70, -v71
    ds_write2_b32 v36, v35, v49 offset0:72 offset1:144
    v_pk_mul_f32 v[40:41], v[68:69], v[94:95] op_sel_hi:[0,1]
    v_pk_mul_f32 v[42:43], v[66:67], v[96:97] op_sel_hi:[0,1]
    v_pk_fma_f32 v[72:73], v[68:69], v[94:95], v[40:41] op_sel:[1,1,0] op_sel_hi:[1,0,1] neg_lo:[0,1,0]
    v_pk_fma_f32 v[66:67], v[66:67], v[96:97], v[42:43] op_sel:[1,1,0] op_sel_hi:[1,0,1] neg_lo:[0,1,0]
    v_cvt_pk_bf16_f32 v35, v72, -v73
    v_cvt_pk_bf16_f32 v48, v66, -v67
    ds_write_b32 v33, v35 offset:864
    ds_write_b32 v33, v48 offset:1152
    v_pk_mul_f32 v[40:41], v[68:69], v[96:97] op_sel_hi:[0,1]
    v_pk_mul_f32 v[42:43], v[70:71], v[96:97] op_sel_hi:[0,1]
    v_pk_mul_f32 v[44:45], v[72:73], v[96:97] op_sel_hi:[0,1]
    v_pk_fma_f32 v[68:69], v[68:69], v[96:97], v[40:41] op_sel:[1,1,0] op_sel_hi:[1,0,1] neg_lo:[0,1,0]
    v_pk_fma_f32 v[70:71], v[70:71], v[96:97], v[42:43] op_sel:[1,1,0] op_sel_hi:[1,0,1] neg_lo:[0,1,0]
    v_pk_fma_f32 v[72:73], v[72:73], v[96:97], v[44:45] op_sel:[1,1,0] op_sel_hi:[1,0,1] neg_lo:[0,1,0]
    v_cvt_pk_bf16_f32 v35, v68, -v69
    v_cvt_pk_bf16_f32 v48, v70, -v71
    v_cvt_pk_bf16_f32 v49, v72, -v73
    ds_write2_b32 v37, v35, v48 offset0:72 offset1:144
    ds_write_b32 v33, v49 offset:2016
    v_pk_mul_f32 v[40:41], v[66:67], v[96:97] op_sel_hi:[0,1]
    v_pk_mul_f32 v[42:43], v[68:69], v[96:97] op_sel_hi:[0,1]
    v_pk_mul_f32 v[44:45], v[70:71], v[96:97] op_sel_hi:[0,1]
    v_pk_mul_f32 v[46:47], v[72:73], v[96:97] op_sel_hi:[0,1]
    v_pk_fma_f32 v[66:67], v[66:67], v[96:97], v[40:41] op_sel:[1,1,0] op_sel_hi:[1,0,1] neg_lo:[0,1,0]
    v_pk_fma_f32 v[68:69], v[68:69], v[96:97], v[42:43] op_sel:[1,1,0] op_sel_hi:[1,0,1] neg_lo:[0,1,0]
    v_pk_fma_f32 v[70:71], v[70:71], v[96:97], v[44:45] op_sel:[1,1,0] op_sel_hi:[1,0,1] neg_lo:[0,1,0]
    v_pk_fma_f32 v[72:73], v[72:73], v[96:97], v[46:47] op_sel:[1,1,0] op_sel_hi:[1,0,1] neg_lo:[0,1,0]
    v_cvt_pk_bf16_f32 v35, v66, -v67
    v_cvt_pk_bf16_f32 v48, v68, -v69
    v_cvt_pk_bf16_f32 v49, v70, -v71
    v_cvt_pk_bf16_f32 v50, v72, -v73
    ds_write2_b32 v38, v35, v48 offset0:0 offset1:72
    ds_write2_b32 v38, v49, v50 offset0:144 offset1:216
    v_pk_mul_f32 v[40:41], v[66:67], v[96:97] op_sel_hi:[0,1]
    v_pk_mul_f32 v[42:43], v[68:69], v[96:97] op_sel_hi:[0,1]
    v_pk_mul_f32 v[44:45], v[70:71], v[96:97] op_sel_hi:[0,1]
    v_pk_mul_f32 v[46:47], v[72:73], v[96:97] op_sel_hi:[0,1]
    v_pk_fma_f32 v[66:67], v[66:67], v[96:97], v[40:41] op_sel:[1,1,0] op_sel_hi:[1,0,1] neg_lo:[0,1,0]
    v_pk_fma_f32 v[68:69], v[68:69], v[96:97], v[42:43] op_sel:[1,1,0] op_sel_hi:[1,0,1] neg_lo:[0,1,0]
    v_pk_fma_f32 v[70:71], v[70:71], v[96:97], v[44:45] op_sel:[1,1,0] op_sel_hi:[1,0,1] neg_lo:[0,1,0]
    v_pk_fma_f32 v[72:73], v[72:73], v[96:97], v[46:47] op_sel:[1,1,0] op_sel_hi:[1,0,1] neg_lo:[0,1,0]
    v_cvt_pk_bf16_f32 v35, v66, -v67
    v_cvt_pk_bf16_f32 v48, v68, -v69
    v_cvt_pk_bf16_f32 v49, v70, -v71
    v_cvt_pk_bf16_f32 v50, v72, -v73
    ds_write2_b32 v39, v35, v48 offset0:0 offset1:72
    ds_write2_b32 v39, v49, v50 offset0:144 offset1:216
    ds_read_b128 a[32:35], v34 offset:0
    ds_read_b128 a[36:39], v34 offset:64
    ds_read_b128 a[40:43], v34 offset:128
    ds_read_b128 a[44:47], v34 offset:192
    v_pk_mul_f32 v[40:41], v[66:67], v[96:97] op_sel_hi:[0,1]
    v_pk_mul_f32 v[42:43], v[68:69], v[96:97] op_sel_hi:[0,1]
    v_pk_mul_f32 v[44:45], v[70:71], v[96:97] op_sel_hi:[0,1]
    v_pk_mul_f32 v[46:47], v[72:73], v[96:97] op_sel_hi:[0,1]
    v_pk_fma_f32 v[66:67], v[66:67], v[96:97], v[40:41] op_sel:[1,1,0] op_sel_hi:[1,0,1] neg_lo:[0,1,0]
    v_pk_fma_f32 v[68:69], v[68:69], v[96:97], v[42:43] op_sel:[1,1,0] op_sel_hi:[1,0,1] neg_lo:[0,1,0]
    v_pk_fma_f32 v[70:71], v[70:71], v[96:97], v[44:45] op_sel:[1,1,0] op_sel_hi:[1,0,1] neg_lo:[0,1,0]
    v_pk_fma_f32 v[72:73], v[72:73], v[96:97], v[46:47] op_sel:[1,1,0] op_sel_hi:[1,0,1] neg_lo:[0,1,0]
    v_cvt_pk_bf16_f32 v35, v66, -v67
    v_cvt_pk_bf16_f32 v48, v68, -v69
    v_cvt_pk_bf16_f32 v49, v70, -v71
    v_cvt_pk_bf16_f32 v50, v72, -v73
    ds_write2_b32 v36, v35, v48 offset0:0 offset1:72
    ds_write2_b32 v36, v49, v50 offset0:144 offset1:216
    v_pk_mul_f32 v[40:41], v[66:67], v[96:97] op_sel_hi:[0,1]
    v_pk_mul_f32 v[42:43], v[68:69], v[96:97] op_sel_hi:[0,1]
    v_pk_mul_f32 v[44:45], v[70:71], v[96:97] op_sel_hi:[0,1]
    v_pk_mul_f32 v[46:47], v[72:73], v[96:97] op_sel_hi:[0,1]
    v_pk_fma_f32 v[66:67], v[66:67], v[96:97], v[40:41] op_sel:[1,1,0] op_sel_hi:[1,0,1] neg_lo:[0,1,0]
    v_pk_fma_f32 v[68:69], v[68:69], v[96:97], v[42:43] op_sel:[1,1,0] op_sel_hi:[1,0,1] neg_lo:[0,1,0]
    v_pk_fma_f32 v[70:71], v[70:71], v[96:97], v[44:45] op_sel:[1,1,0] op_sel_hi:[1,0,1] neg_lo:[0,1,0]
    v_pk_fma_f32 v[72:73], v[72:73], v[96:97], v[46:47] op_sel:[1,1,0] op_sel_hi:[1,0,1] neg_lo:[0,1,0]
    v_cvt_pk_bf16_f32 v35, v66, -v67
    v_cvt_pk_bf16_f32 v48, v68, -v69
    v_cvt_pk_bf16_f32 v49, v70, -v71
    v_cvt_pk_bf16_f32 v50, v72, -v73
    ds_write2_b32 v37, v35, v48 offset0:0 offset1:72
    ds_write2_b32 v37, v49, v50 offset0:144 offset1:216
    s_waitcnt lgkmcnt(4)
    v_mfma_f32_16x16x32_bf16 a[64:67], a[0:3], a[32:35], 0
    v_mfma_f32_16x16x32_bf16 a[68:71], a[16:19], a[32:35], 0
    s_nop 0
    v_pk_mul_f32 v[40:41], v[66:67], v[96:97] op_sel_hi:[0,1]
    v_pk_mul_f32 v[42:43], v[68:69], v[96:97] op_sel_hi:[0,1]
    v_pk_mul_f32 v[44:45], v[70:71], v[96:97] op_sel_hi:[0,1]
    v_pk_mul_f32 v[46:47], v[72:73], v[96:97] op_sel_hi:[0,1]
    v_pk_fma_f32 v[66:67], v[66:67], v[96:97], v[40:41] op_sel:[1,1,0] op_sel_hi:[1,0,1] neg_lo:[0,1,0]
    v_pk_fma_f32 v[68:69], v[68:69], v[96:97], v[42:43] op_sel:[1,1,0] op_sel_hi:[1,0,1] neg_lo:[0,1,0]
    v_pk_fma_f32 v[70:71], v[70:71], v[96:97], v[44:45] op_sel:[1,1,0] op_sel_hi:[1,0,1] neg_lo:[0,1,0]
    v_pk_fma_f32 v[72:73], v[72:73], v[96:97], v[46:47] op_sel:[1,1,0] op_sel_hi:[1,0,1] neg_lo:[0,1,0]
    v_cvt_pk_bf16_f32 v35, v66, -v67
    v_cvt_pk_bf16_f32 v48, v68, -v69
    v_cvt_pk_bf16_f32 v49, v70, -v71
    v_cvt_pk_bf16_f32 v50, v72, -v73
    ds_write2_b32 v38, v35, v48 offset0:0 offset1:72
    ds_write2_b32 v38, v49, v50 offset0:144 offset1:216
    v_mfma_f32_16x16x32_bf16 a[64:67], a[4:7], a[36:39], a[64:67]
    v_mfma_f32_16x16x32_bf16 a[68:71], a[20:23], a[36:39], a[68:71]
    v_pk_mul_f32 v[40:41], v[66:67], v[96:97] op_sel_hi:[0,1]
    v_pk_mul_f32 v[42:43], v[68:69], v[96:97] op_sel_hi:[0,1]
    v_pk_mul_f32 v[44:45], v[70:71], v[96:97] op_sel_hi:[0,1]
    v_pk_mul_f32 v[46:47], v[72:73], v[96:97] op_sel_hi:[0,1]
    v_pk_fma_f32 v[66:67], v[66:67], v[96:97], v[40:41] op_sel:[1,1,0] op_sel_hi:[1,0,1] neg_lo:[0,1,0]
    v_pk_fma_f32 v[68:69], v[68:69], v[96:97], v[42:43] op_sel:[1,1,0] op_sel_hi:[1,0,1] neg_lo:[0,1,0]
    v_pk_fma_f32 v[70:71], v[70:71], v[96:97], v[44:45] op_sel:[1,1,0] op_sel_hi:[1,0,1] neg_lo:[0,1,0]
    v_pk_fma_f32 v[72:73], v[72:73], v[96:97], v[46:47] op_sel:[1,1,0] op_sel_hi:[1,0,1] neg_lo:[0,1,0]
    v_cvt_pk_bf16_f32 v35, v66, -v67
    v_cvt_pk_bf16_f32 v48, v68, -v69
    v_cvt_pk_bf16_f32 v49, v70, -v71
    v_cvt_pk_bf16_f32 v50, v72, -v73
    ds_write2_b32 v39, v35, v48 offset0:0 offset1:72
    ds_write2_b32 v39, v49, v50 offset0:144 offset1:216
    v_mfma_f32_16x16x32_bf16 a[64:67], a[8:11], a[40:43], a[64:67]
    v_mfma_f32_16x16x32_bf16 a[68:71], a[24:27], a[40:43], a[68:71]
    ds_read_b128 a[48:51], v34 offset:0
    ds_read_b128 a[52:55], v34 offset:64
    ds_read_b128 a[56:59], v34 offset:128
    ds_read_b128 a[60:63], v34 offset:192
    v_mfma_f32_16x16x32_bf16 a[64:67], a[12:15], a[44:47], a[64:67]
    v_mfma_f32_16x16x32_bf16 a[68:71], a[28:31], a[44:47], a[68:71]
    s_waitcnt lgkmcnt(0)
    v_mfma_f32_16x16x32_bf16 a[72:75], a[0:3], a[48:51], 0
    v_mfma_f32_16x16x32_bf16 a[76:79], a[16:19], a[48:51], 0
    v_mfma_f32_16x16x32_bf16 a[72:75], a[4:7], a[52:55], a[72:75]
    v_mfma_f32_16x16x32_bf16 a[76:79], a[20:23], a[52:55], a[76:79]
    v_mfma_f32_16x16x32_bf16 a[72:75], a[8:11], a[56:59], a[72:75]
    v_mfma_f32_16x16x32_bf16 a[76:79], a[24:27], a[56:59], a[76:79]
    v_mfma_f32_16x16x32_bf16 a[72:75], a[12:15], a[60:63], a[72:75]
    v_mfma_f32_16x16x32_bf16 a[76:79], a[28:31], a[60:63], a[76:79]
    ds_write_b128 v32, a[64:67] offset:0
    ds_write_b128 v32, a[68:71] offset:1024
    s_nop 4
    ds_write_b128 v32, a[72:75] offset:2048
    ds_write_b128 v32, a[76:79] offset:3072
    s_lshl_b32 s31, s30, 8
    v_add_u32 v28, s31, v0
    s_lshl_b32 s31, s30, 2
    s_add_u32 s31, s31, s28
    s_mul_i32 s31, s31, 14336
    v_lshl_add_u32 v28, v2, 7, s31
    v_lshl_add_u32 v28, v3, 28, v28
    buffer_load_dword v255, v28, s[12:15], 0 offen offset:0
    buffer_load_dword v255, v28, s[12:15], 0 offen offset:2048
    v_add_u32 v28, 4096, v28
    buffer_load_dword v255, v28, s[12:15], 0 offen offset:0
    buffer_load_dword v255, v28, s[12:15], 0 offen offset:2048
    v_add_u32 v28, 4096, v28
    buffer_load_dword v255, v28, s[12:15], 0 offen offset:0
    buffer_load_dword v255, v28, s[12:15], 0 offen offset:2048
    v_add_u32 v28, 4096, v28
    buffer_load_dword v255, v28, s[12:15], 0 offen offset:0
    s_add_u32 m0, s3, 0
    s_nop 0
    buffer_load_dwordx4 v246, s[12:15], s75 offen offset:0 lds
    buffer_load_dwordx4 v247, s[12:15], s75 offen offset:1024 lds
    buffer_load_dwordx4 v248, s[12:15], s75 offen offset:2048 lds
    buffer_load_dwordx4 v249, s[12:15], s75 offen offset:3072 lds
    s_add_u32 s75, s75, 32768
    s_cmp_eq_u32 s75, s25
    s_cselect_b32 s27, 458752, 0
    s_sub_u32 s75, s75, s27
    s_add_u32 m0, s3, 4096
    s_nop 0
    buffer_load_dwordx4 v246, s[12:15], s75 offen offset:0 lds
    buffer_load_dwordx4 v247, s[12:15], s75 offen offset:1024 lds
    buffer_load_dwordx4 v248, s[12:15], s75 offen offset:2048 lds
    buffer_load_dwordx4 v249, s[12:15], s75 offen offset:3072 lds
    s_add_u32 s75, s75, 32768
    s_cmp_eq_u32 s75, s25
    s_cselect_b32 s27, 458752, 0
    s_sub_u32 s75, s75, s27
    s_add_u32 m0, s3, 32768
    s_nop 0
    buffer_load_dwordx4 v246, s[12:15], s75 offen offset:0 lds
    buffer_load_dwordx4 v247, s[12:15], s75 offen offset:1024 lds
    buffer_load_dwordx4 v248, s[12:15], s75 offen offset:2048 lds
    buffer_load_dwordx4 v249, s[12:15], s75 offen offset:3072 lds
    s_add_u32 s75, s75, 32768
    s_cmp_eq_u32 s75, s25
    s_cselect_b32 s27, 458752, 0
    s_sub_u32 s75, s75, s27
    s_add_u32 m0, s3, 36864
    s_nop 0
    buffer_load_dwordx4 v246, s[12:15], s75 offen offset:0 lds
    buffer_load_dwordx4 v247, s[12:15], s75 offen offset:1024 lds
    buffer_load_dwordx4 v248, s[12:15], s75 offen offset:2048 lds
    buffer_load_dwordx4 v249, s[12:15], s75 offen offset:3072 lds
    s_add_u32 s75, s75, 32768
    s_cmp_eq_u32 s75, s25
    s_cselect_b32 s27, 458752, 0
    s_sub_u32 s75, s75, s27
    v_lshrrev_b32 v28, 2, v1
    v_lshlrev_b32_e64 v28, 8, v28
    v_lshl_add_u32 v28, v5, 4, v28
    s_lshl_b32 s76, s28, 26
    s_add_u32 s76, s76, 0xb00000
    v_add_u32 v28, s76, v28
    buffer_load_dwordx4 v[30:33], v28, s[16:19], 0 offen sc1
    s_waitcnt lgkmcnt(0)
    s_barrier
    s_lshr_b32 s33, s28, 1
    s_and_b32 s34, s28, 1
    s_mul_i32 s31, s33, 9216
    s_lshl_b32 s32, s34, 11
    s_add_u32 s31, s31, s32
    s_add_u32 s31, s31, 141312
    v_add_u32_e64 v34, s31, v6
    ds_read_b128 v[228:231], v34 offset:0
    ds_read_b128 v[232:235], v34 offset:1024
    ds_read_b128 v[236:239], v34 offset:4608
    ds_read_b128 v[240:243], v34 offset:5632
    s_mul_i32 s32, s33, 4608
    s_lshl_b32 s31, s34, 8
    s_add_u32 s31, s31, s32
    s_add_u32 s31, s31, 132096
    v_mov_b32 v35, 0x100
    v_lshlrev_b32_e64 v35, v3, v35
    v_and_b32 v35, 0xe00, v35
    v_lshl_add_u32 v35, v2, 4, v35
    v_add_u32 v29, s31, v35
    v_mov_b32 v35, 0
    v_lshl_add_u32 v36, v1, 2, s31
    ds_write_b32 v36, v35
    v_and_b32 v37, 0x7f, v0
    v_cmp_eq_u32 vcc, 0, v37
    s_nop 1
    v_cndmask_b32 v37, 0, v25, vcc
    v_and_b32 v35, 1, v0
    v_cmp_eq_u32 vcc, 0, v35
    s_waitcnt lgkmcnt(1)
    v_add_f32 v228, v228, v236
    v_add_f32 v229, v229, v237
    v_add_f32 v230, v230, v238
    v_add_f32 v231, v231, v239
    v_add_f32 v232, v232, v240
    v_add_f32 v233, v233, v241
    v_add_f32 v234, v234, v242
    v_add_f32 v235, v235, v243
    v_add_f32_e64 v228, v228, v37
    v_cvt_pk_bf16_f32 v40, v228, v229
    v_cvt_pk_bf16_f32 v41, v230, v231
    v_cvt_pk_bf16_f32 v42, v232, v233
    v_cvt_pk_bf16_f32 v43, v234, v235
    v_cvt_pk_bf16_f32 v44, v228, v228
    v_cvt_pk_bf16_f32 v45, v229, v230
    v_cvt_pk_bf16_f32 v46, v230, v230
    v_cvt_pk_bf16_f32 v47, v231, v232
    v_cvt_pk_bf16_f32 v48, v228, v228
    v_cvt_pk_bf16_f32 v49, v228, v229
    v_cvt_pk_bf16_f32 v50, v229, v229
    v_cvt_pk_bf16_f32 v51, v230, v230
    v_cvt_pk_bf16_f32 v52, v232, v232
    v_cvt_pk_bf16_f32 v53, v232, v233
    v_cvt_pk_bf16_f32 v54, v233, v233
    v_cvt_pk_bf16_f32 v55, v234, v234
    v_cndmask_b32_e64 v34, v229, v228, vcc
    v_cvt_pk_bf16_f32 v56, v228, v228
    v_cvt_pk_bf16_f32 v57, v228, v228
    v_cvt_pk_bf16_f32 v58, v34, v229
    v_cvt_pk_bf16_f32 v59, v229, v229
    v_cndmask_b32_e64 v34, v231, v230, vcc
    v_cvt_pk_bf16_f32 v60, v230, v230
    v_cvt_pk_bf16_f32 v61, v230, v230
    v_cvt_pk_bf16_f32 v62, v34, v231
    v_cvt_pk_bf16_f32 v63, v231, v231
    v_cndmask_b32_e64 v34, v233, v232, vcc
    v_cvt_pk_bf16_f32 v64, v232, v232
    v_cvt_pk_bf16_f32 v65, v232, v232
    v_cvt_pk_bf16_f32 v66, v34, v233
    v_cvt_pk_bf16_f32 v67, v233, v233
    v_cndmask_b32_e64 v34, v235, v234, vcc
    v_cvt_pk_bf16_f32 v68, v234, v234
    v_cvt_pk_bf16_f32 v69, v234, v234
    v_cvt_pk_bf16_f32 v70, v34, v235
    v_cvt_pk_bf16_f32 v71, v235, v235
    s_bfm_b64 exec, 16, 0
    ds_write_b128 v29, v[40:43] offset:512
    s_bfm_b64 exec, 16, 16
    ds_write_b128 v29, v[44:47] offset:512
    s_mov_b64 exec, -1
    s_bfm_b64 exec, 16, 32
    ds_write_b128 v29, v[48:51] offset:512
    ds_write_b128 v29, v[52:55] offset:1024
    s_mov_b64 exec, -1
    s_bfm_b64 exec, 16, 48
    ds_write_b128 v29, v[56:59] offset:512
    ds_write_b128 v29, v[60:63] offset:1024
    s_mov_b64 exec, -1
    s_bfm_b64 exec, 16, 48
    ds_write_b128 v29, v[64:67] offset:1536
    ds_write_b128 v29, v[68:71] offset:2048
    s_mov_b64 exec, -1
    s_waitcnt vmcnt(0)
    s_cmp_lg_u32 s28, 0
    s_cbranch_scc1 XP_11
    v_xor_b32 v31, v31, v30
    v_xor_b32 v32, v32, v30
    v_xor_b32 v33, v33, v30
    v_xor_b32 v30, s54, v30
    v_or3_b32 v31, v31, v32, v33
    v_or_b32 v30, v30, v31
    v_cmp_ne_u32 vcc, 0, v30
    s_mov_b32 s81, 0x10000
    s_cbranch_vccz OK_13
POLL_12:
    s_sub_u32 s81, s81, 1
    s_cbranch_scc1 OK_13
    s_sleep 8
    buffer_load_dwordx4 v[30:33], v28, s[16:19], 0 offen sc1
    s_waitcnt vmcnt(0)
    v_xor_b32 v31, v31, v30
    v_xor_b32 v32, v32, v30
    v_xor_b32 v33, v33, v30
    v_xor_b32_e64 v30, s54, v30
    v_or3_b32 v31, v31, v32, v33
    v_or_b32 v30, v30, v31
    v_cmp_ne_u32 vcc, 0, v30
    s_nop 1
    s_cbranch_vccnz POLL_12
OK_13:
XP_11:
    s_barrier
    v_lshrrev_b32 v28, 1, v0
    v_lshlrev_b32 v28, 13, v28
    v_and_b32 v29, 1, v0
    v_lshl_add_u32 v28, v29, 4, v28
    v_add_u32 v29, -8184, v28
    v_cmp_gt_u32 vcc, 2, v2
    s_lshl_b32 s35, s78, 5
    s_add_u32 s35, s35, 0x700000
    v_cndmask_b32_e64 v29, 2.0, v29, vcc
    buffer_load_dwordx4 v[232:235], v28, s[16:19], s35 offen sc1
    buffer_load_dwordx2 v[230:231], v29, s[16:19], s35 offen sc1
    v_add_u32 v28, 0x100000, v28
    v_add_u32 v29, 0x100000, v29
    buffer_load_dwordx4 v[240:243], v28, s[16:19], s35 offen sc1
    buffer_load_dwordx2 v[238:239], v29, s[16:19], s35 offen sc1
    s_lshr_b32 s74, s28, 1
    s_mul_i32 s31, s74, 16704
    s_and_b32 s32, s28, 1
    s_lshl_b32 s32, s32, 8
    s_add_u32 s31, s31, s32
    s_add_u32 s31, s31, 98360
    v_mul_u32_u24 v8, 4160, v4
    v_lshl_add_u32 v8, v5, 3, v8
    v_lshlrev_b32 v10, 4, v3
    v_sub_u32 v8, v8, v10
    v_add_u32_e64 v8, s31, v8
    s_mul_i32 s31, s74, 4608
    s_sub_u32 s31, s31, s32
    s_add_u32 s31, s31, 132384
    s_nop 0
    v_lshl_add_u32 v9, v2, 5, v10
    v_add_u32 v9, s31, v9
    s_lshl_b32 s31, s80, 7
    v_lshl_add_u32 v12, v3, 4, s31
    v_lshl_add_u32 v11, v2, 10, v12
    s_lshl_b32 s31, s79, 16
    s_lshl_b32 s32, s28, 14
    s_add_u32 s31, s31, s32
    v_add_u32 v11, s31, v11
    s_mul_i32 s31, s79, 229376
    s_mul_i32 s32, s28, 14336
    s_add_u32 s31, s31, s32
    s_xor_b32 s72, s28, 0
    s_mul_i32 s72, s72, 57344
    s_add_u32 s72, s72, s31
    s_xor_b32 s73, s28, 1
    s_mul_i32 s73, s73, 57344
    s_add_u32 s73, s73, s31
    s_xor_b32 s76, s28, 2
    s_mul_i32 s76, s76, 57344
    s_add_u32 s76, s76, s31
    s_xor_b32 s77, s28, 3
    s_mul_i32 s77, s77, 57344
    s_add_u32 s77, s77, s31
    s_lshl_b32 s26, s24, 10
    v_add_u32_e64 v13, s26, v6
    s_mov_b32 s35, 98304
    v_and_b32_e64 v52, 1, v0
    v_mul_u32_u24 v52, 16696, v52
    v_lshl_add_u32 v52, v0, 3, v52
    v_add_u32 v52, 98336, v52
    v_bfe_u32 v54, v0, 3, 2
    v_mul_u32_u24 v54, 4160, v54
    v_and_b32_e64 v55, 7, v1
    v_lshl_add_u32 v54, v55, 2, v54
    v_bfe_u32 v55, v0, 5, 1
    v_mul_u32_u24 v55, 16704, v55
    v_add3_u32 v54, v54, v55, s35
    v_mov_b32_e64 v55, 0
    ds_write_b32 v54, v55
    s_waitcnt vmcnt(0)
    ds_write_b128 v52, v[232:235] offset:0
    s_nop 0
    v_mov_b32_dpp v230, v234 row_shr:2 row_mask:0xf bank_mask:0xf
    v_mov_b32_dpp v231, v235 row_shr:2 row_mask:0xf bank_mask:0xf
    v_alignbit_b32 v28, v232, v231, 16
    v_alignbit_b32 v29, v233, v232, 16
    v_alignbit_b32 v30, v234, v233, 16
    v_alignbit_b32 v31, v235, v234, 16
    ds_write_b128 v52, v[28:31] offset:4160
    v_pk_mov_b32 v[32:33], v[230:231], v[232:233] op_sel:[1,0]
    v_pk_mov_b32 v[34:35], v[232:233], v[234:235] op_sel:[1,0]
    ds_write_b128 v52, v[32:35] offset:8320
    v_alignbit_b32 v36, v231, v230, 16
    v_alignbit_b32 v37, v232, v231, 16
    v_alignbit_b32 v38, v233, v232, 16
    v_alignbit_b32 v39, v234, v233, 16
    ds_write_b128 v52, v[36:39] offset:12480
    ds_write_b128 v52, v[240:243] offset:2048
    v_mov_b32_dpp v238, v242 row_shr:2 row_mask:0xf bank_mask:0xf
    v_mov_b32_dpp v239, v243 row_shr:2 row_mask:0xf bank_mask:0xf
    v_alignbit_b32 v40, v240, v239, 16
    v_alignbit_b32 v41, v241, v240, 16
    v_alignbit_b32 v42, v242, v241, 16
    v_alignbit_b32 v43, v243, v242, 16
    ds_write_b128 v52, v[40:43] offset:6208
    v_pk_mov_b32 v[44:45], v[238:239], v[240:241] op_sel:[1,0]
    v_pk_mov_b32 v[46:47], v[240:241], v[242:243] op_sel:[1,0]
    ds_write_b128 v52, v[44:47] offset:10368
    v_alignbit_b32 v48, v239, v238, 16
    v_alignbit_b32 v49, v240, v239, 16
    v_alignbit_b32 v50, v241, v240, 16
    v_alignbit_b32 v51, v242, v241, 16
    ds_write_b128 v52, v[48:51] offset:14528
    ds_read_b64_tr_b16 a[0:1], v250 offset:0
    ds_read_b64_tr_b16 a[2:3], v250 offset:2048
    ds_read_b64_tr_b16 a[4:5], v250 offset:8
    ds_read_b64_tr_b16 a[6:7], v250 offset:2056
    ds_read_b64_tr_b16 a[8:9], v251 offset:0
    ds_read_b64_tr_b16 a[10:11], v251 offset:2048
    ds_read_b64_tr_b16 a[12:13], v251 offset:8
    ds_read_b64_tr_b16 a[14:15], v251 offset:2056
    s_lshl_b32 s70, s70, 2
    s_add_u32 s70, s70, s28
    s_lshl_b32 s31, s70, 7
    s_add_u32 s31, s31, 0xb09000
    s_cmp_eq_u32 s70, 0
    s_cselect_b32 s70, 0xb00080, s31
    s_waitcnt vmcnt(0) lgkmcnt(0)
    s_branch JOIN_3
END_1:
    s_endpgm
.fill 512, 4, 0xBF810000

.section .rodata,"a"
.p2align 6
.amdhsa_kernel parallel_sum__ssm_conv_s4__dense_activation_squared_relu__prompt_kernel
  .amdhsa_next_free_vgpr 512
  .amdhsa_next_free_sgpr 102
  .amdhsa_accum_offset 256
  .amdhsa_group_segment_fixed_size 0
  .amdhsa_kernarg_size 136
  .amdhsa_user_sgpr_count 2
  .amdhsa_user_sgpr_kernarg_segment_ptr 1
  .amdhsa_system_sgpr_workgroup_id_x 1
.end_amdhsa_kernel
```
